```python
import torch

def _softmax(x, axis=-1):
    return torch.softmax(x, dim=axis)
def _gelu(x):
    return torch.nn.functional.gelu(x, approximate="tanh")
def _silu(x):
    return torch.nn.functional.silu(x)
def _sigmoid(x):
    return torch.sigmoid(x)
def _layernorm(x, axis=-1, eps=1e-5):
    m = x.mean(dim=axis, keepdim=True)
    v = x.var(dim=axis, keepdim=True, unbiased=False)
    return (x - m) / torch.sqrt(v + eps)
def _scatter_add(tgt, idx, src, axis=0):
    return tgt.clone().index_add_(axis, idx, src)
def _segment_sum(src, seg, n):
    out = torch.zeros((n,) + src.shape[1:], dtype=src.dtype)
    return out.index_add_(0, seg, src)
def _pad(x, pw):
    flat = tuple(v for pair in reversed(pw) for v in pair)
    return torch.nn.functional.pad(x, flat)

kernel_name = 'parallel_sum__softmax_full_mha__glu_gated_reglu__prompt'

def setup_inputs():

    _w = (lambda a: (lambda t: t.to(torch.bfloat16) if t.is_floating_point() else t)(torch.as_tensor(a)))
    def _A_setup():
        B, S, D = 1, 2048, 448
        return {
            "x": _w((lambda *s: torch.randn(*s, dtype=torch.bfloat16) * 0.05)(B, S, D)),
            "wqkv": _w((lambda *s: torch.randn(*s, dtype=torch.bfloat16) * 0.05)(D, 3 * D)),
            "wo": _w((lambda *s: torch.randn(*s, dtype=torch.bfloat16) * 0.05)(D, D)),
        }
    _A_in = _A_setup()

    def _B_setup():
        B, S, D, F = 1, 2048, 448, 1792
        return {
            "x": _w((lambda *s: torch.randn(*s, dtype=torch.bfloat16) * 0.05)(B, S, D)),
            "W_gate": _w((lambda *s: torch.randn(*s, dtype=torch.bfloat16) * 0.4)(D, F) * (2.0 / D) ** 0.5),
            "W_up": _w((lambda *s: torch.randn(*s, dtype=torch.bfloat16) * 0.4)(D, F) * (2.0 / D) ** 0.5),
            "W_down": _w((lambda *s: torch.randn(*s, dtype=torch.bfloat16) * 0.4)(F, D) * (1.0 / F) ** 0.5),
        }
    _B_in = _B_setup()

    return {
        "A_x": _A_in["x"],
        "A_wqkv": _A_in["wqkv"],
        "A_wo": _A_in["wo"],
        "B_x": _B_in["x"],
        "B_W_gate": _B_in["W_gate"],
        "B_W_up": _B_in["W_up"],
        "B_W_down": _B_in["W_down"],
    }

def reference(A_x, A_wqkv, A_wo, B_x, B_W_gate, B_W_up, B_W_down):
    def _A_ref(x, wqkv, wo):
        B, S, D = x.shape
        H = 16; Dh = D // H
        qkv = (lambda x, *d: x.permute(*d))((x @ wqkv).reshape(B, S, 3, H, Dh), 2, 0, 3, 1, 4)
        q, k, v = qkv[0], qkv[1], qkv[2]
        scale = Dh ** -0.5
        scores = torch.einsum("bhqd,bhkd->bhqk", q, k) * scale
        p = _softmax(scores, axis=-1)
        o = torch.einsum("bhqk,bhkd->bhqd", p, v)
        return (lambda x, *d: x.permute(*d))(o, 0, 2, 1, 3).reshape(B, S, D) @ wo

    def _B_ref(x, W_gate, W_up, W_down):
        gate = torch.einsum("bsd,df->bsf", x, W_gate)
        up = torch.einsum("bsd,df->bsf", x, W_up)
        gate = gate * (lambda x, dt: x.to(dt))(gate > 0, gate.dtype)
        h = gate * up
        return torch.einsum("bsf,fd->bsd", h, W_down)

    x = A_x
    xn = _layernorm(x, axis=-1)
    return x + _A_ref(xn, A_wqkv, A_wo) + _B_ref(xn, B_W_gate, B_W_up, B_W_down)
```

```asm
; @launch grid=(256,1,1) block=(512,1,1) lds=163840
.amdgcn_target "amdgcn-amd-amdhsa--gfx950"
.text
.globl parallel_sum__softmax_full_mha__glu_gated_reglu__prompt_kernel
.p2align 8
.type parallel_sum__softmax_full_mha__glu_gated_reglu__prompt_kernel,@function
parallel_sum__softmax_full_mha__glu_gated_reglu__prompt_kernel:
    s_cmp_ge_u32 s2, 256
    s_cbranch_scc1 L_end
    s_load_dwordx4 s[20:23], s[0:1], 0
    s_load_dwordx4 s[36:39], s[0:1], 32
    s_load_dwordx2 s[44:45], s[0:1], 72
    s_getpc_b64 s[10:11]
L_pc:
    v_lshrrev_b32 v10, 5, v0
    s_lshr_b32 s65, s2, 3
    s_lshl_b32 s82, s65, 4
    v_add_lshl_u32 v10, v10, s82, 7
    v_min_u32 v10, L_end-L_pc, v10
    global_load_dword v246, v10, s[10:11]
    v_lshrrev_b32 v1, 6, v0
    v_bfe_u32 v2, v0, 3, 3
    v_readfirstlane_b32 s60, v1
    s_lshr_b32 s18, s2, 5
    s_and_b32 s18, s18, 4
    s_and_b32 s19, s65, 4
    s_and_b32 s82, s65, 7
    s_and_b32 s83, s2, 1
    v_and_b32 v3, 7, v0
    s_lshl3_add_u32 s61, s83, s82
    v_lshrrev_b32 v4, 1, v2
    s_bfe_u32 s82, s2, 0x20001
    v_xor_b32 v4, v4, v3
    s_lshr_b32 s86, s2, 6
    v_xor_b32 v5, s18, v1
    s_lshl2_add_u32 s62, s86, s82
    v_lshl_add_u32 v5, v5, 4, v2
    s_mul_i32 s12, s61, 114688
    v_mul_u32_u24 v5, 896, v5
    s_lshl4_add_u32 s17, s61, s62
    v_lshl_add_u32 v52, v4, 4, v5
    s_lshl3_add_u32 s17, s17, s60
    v_xor_b32 v4, 64, v52
    s_mul_i32 s87, s17, 896
    v_add_u32 v53, 7168, v4
    s_xor_b32 s82, s60, s18
    v_and_b32 v245, 63, v0
    s_lshl_b32 s72, s82, 11
    v_min_u32 v8, 56, v245
    s_xor_b32 s82, s61, s86
    v_add_u32 v9, 8, v8
    s_and_b32 s82, s82, 3
    s_mul_i32 s83, s82, 0x1111
    v_lshlrev_b32 v8, 4, v8
    s_xor_b32 s83, s83, 0x3210
    v_lshrrev_b32 v9, 6, v9
    s_lshl_b32 s82, s82, 2
    v_lshl_add_u32 v8, v9, 30, v8
    s_lshr_b32 s82, 0x654654, s82
    v_lshrrev_b32 v4, 2, v0
    s_and_b32 s82, s82, 0xfff
    v_and_b32 v4, 4, v4
    s_pack_ll_b32_b16 s86, s83, s82
    v_xor_b32 v4, v4, v3
    s_lshl_b32 s83, s83, 12
    v_xor_b32 v5, s19, v1
    s_or_b32 s83, s83, s82
    v_lshl_add_u32 v5, v5, 3, v2
    s_bitcmp1_b32 0x66666666, s2
    v_mul_u32_u24 v6, 2688, v5
    s_cselect_b32 s81, s83, s86
    v_lshl_add_u32 v54, v4, 4, v6
    s_and_b32 s86, s81, 7
    v_mul_u32_u24 v6, 3584, v5
    s_lshl_b32 s66, s86, 7
    v_lshl_add_u32 v242, v4, 4, v6
    s_add_u32 s66, s66, s12
    v_xor_b32 v243, 32, v242
    s_mov_b32 m0, s72
    s_waitcnt lgkmcnt(0)
    s_mov_b64 s[24:25], s[22:23]
    s_mov_b32 s22, 1835008
    s_mov_b32 s23, 0x20000
    buffer_load_dwordx4 v[12:15], v8, s[20:23], s87 offen
    buffer_load_dwordx4 v52, s[20:23], s66 offen lds
    s_add_u32 m0, s72, 1024
    s_load_dword s63, s[44:45], 0
    buffer_load_dwordx4 v53, s[20:23], s66 offen lds
    s_xor_b32 s82, s60, s19
    s_lshl_b32 s73, s82, 10
    s_lshl_b32 s82, s62, 2
    s_lshr_b32 s82, 0xd6a730, s82
    s_and_b32 s82, s82, 15
    s_add_u32 s83, s62, 6
    s_cmp_ge_u32 s62, 8
    s_cselect_b32 s75, s83, s82
    s_lshl_b32 s82, s62, 1
    s_lshr_b32 s82, 0xeaaaf500, s82
    s_and_b32 s78, s82, 3
    s_lshl_b32 s13, s75, 7
    s_mul_i32 s67, s86, 172032
    s_add_u32 s67, s67, s13
    s_cmp_eq_u32 s78, 3
    s_cselect_b32 s26, 0, 1204224
    s_mov_b32 s27, 0x20000
    s_add_u32 m0, s73, 65536
    s_mov_b64 s[40:41], s[38:39]
    buffer_load_dwordx4 v54, s[24:27], s67 offen lds
    s_lshl_b32 s16, s62, 7
    s_add_u32 s4, s16, 1536
    s_add_u32 s5, s13, 128
    s_mov_b32 s42, 1605632
    s_mov_b32 s82, 229376
    s_mov_b32 s31, 0x20000
    s_mov_b32 s35, 0x20000
    s_cmp_eq_u32 s78, 0
    s_cselect_b32 s14, s5, s4
    s_cselect_b32 s15, 128, 0
    s_cselect_b32 s70, 172032, s82
    s_cselect_b32 s30, s26, s42
    s_cselect_b32 s34, s26, s42
    s_cselect_b64 vcc, -1, 0
    s_cselect_b64 s[28:29], s[24:25], s[36:37]
    s_cselect_b64 s[32:33], s[24:25], s[38:39]
    v_cndmask_b32 v55, v242, v54, vcc
    s_mul_i32 s68, s86, s70
    v_cndmask_b32 v56, v243, v54, vcc
    s_add_u32 s68, s68, s14
    s_add_u32 s69, s68, s15
    s_add_u32 m0, s73, 98304
    s_mov_b32 s43, 0x20000
    buffer_load_dwordx4 v55, s[28:31], s68 offen lds
    s_add_u32 m0, s73, 131072
    s_mul_i32 s71, s86, 229376
    buffer_load_dwordx4 v56, s[32:35], s69 offen lds
    s_add_u32 s71, s71, s16
    s_bfe_u32 s18, s81, 0x30004
    s_mul_i32 s66, s18, 128
    s_add_u32 s66, s66, s12
    s_mul_i32 s67, s18, 172032
    s_add_u32 s67, s67, s13
    s_mul_i32 s68, s18, s70
    s_add_u32 s68, s68, s14
    s_add_u32 s69, s68, s15
    s_load_dwordx2 s[48:49], s[0:1], 48
    s_load_dwordx2 s[52:53], s[0:1], 16
    s_load_dwordx2 s[56:57], s[0:1], 56
    s_lshr_b32 s77, s60, 2
    s_and_b32 s79, s60, 3
    s_mul_i32 s82, s79, 4128
    s_lshl_b32 s83, s77, 6
    s_lshl_b32 s86, s79, 11
    s_or_b32 s83, s83, s86
    v_and_b32 v2, 31, v0
    v_bfe_u32 v3, v0, 5, 1
    v_bfe_u32 v4, v0, 1, 3
    s_and_b32 s64, s2, 7
    v_xor_b32 v11, v4, v0
    v_xor_b32 v4, v4, v3
    v_lshlrev_b32 v4, 4, v4
    s_mov_b32 s38, 1605632
    v_lshl_add_u32 v4, v2, 7, v4
    v_xor_b32 v48, s82, v4
    v_bfe_u32 v4, v0, 2, 2
    s_mov_b32 s39, 0x20000
    v_and_b32 v5, 11, v0
    v_lshlrev_b32 v5, 3, v5
    v_lshl_add_u32 v5, v4, 7, v5
    s_mov_b32 s46, 16252928
    v_bfe_u32 v6, v0, 4, 1
    v_lshl_add_u32 v5, v3, 10, v5
    v_lshl_add_u32 v5, v6, 5, v5
    s_mov_b32 s47, 0x20000
    v_xor_b32 v5, s83, v5
    v_and_b32 v11, 1, v11
    v_mul_u32_u24 v11, 24, v11
    v_xor_b32 v11, v11, v5
    s_mov_b32 s50, 1605632
    v_add_u32 v60, 65536, v11
    v_mul_u32_u24 v7, 32768, v6
    v_add_u32 v7, v7, v5
    s_mov_b32 s51, 0x20000
    v_xor_b32 v8, 32, v7
    v_add_u32 v9, 32768, v11
    v_cndmask_b32 v7, v7, v11, vcc
    s_mov_b32 s54, 401408
    v_cndmask_b32 v8, v8, v9, vcc
    v_add_u32 v64, 98304, v7
    v_add_u32 v68, 98304, v8
    s_mov_b32 s55, 0x20000
    v_lshl_add_u32 v104, v6, 13, v5
    v_bfe_u32 v5, v0, 4, 2
    v_cmp_eq_u32 vcc, v4, v5
    s_mov_b32 s58, 1835008
    v_mov_b32 v7, 0x3f803f80
    v_xor_b32 v49, 32, v48
    v_xor_b32 v61, 2048, v60
    v_xor_b32 v65, 2048, v64
    s_mov_b32 s59, 0x20000
    v_xor_b32 v69, 2048, v68
    v_xor_b32 v50, 64, v48
    v_xor_b32 v62, 4096, v60
    s_mov_b32 s74, 0xffff0000
    v_xor_b32 v66, 4096, v64
    v_xor_b32 v70, 4096, v68
    v_xor_b32 v51, 96, v48
    s_mov_b32 s88, 0
    v_xor_b32 v63, 6144, v60
    v_xor_b32 v67, 6144, v64
    v_xor_b32 v71, 6144, v68
    s_mov_b32 s89, -1
    v_cndmask_b32 v112, 0, v7, vcc
    v_cndmask_b32 v113, 0, v7, vcc
    v_cndmask_b32 v114, 0, v7, vcc
    s_lshl2_add_u32 s76, s61, s79
    v_cndmask_b32 v115, 0, v7, vcc
    v_mov_b32 v16, 0
    v_mov_b32 v17, 0
    s_waitcnt vmcnt(5)
    v_dot2c_f32_bf16 v16, v7, v12
    v_dot2c_f32_bf16 v17, v12, v12
    v_dot2c_f32_bf16 v16, v7, v13
    v_dot2c_f32_bf16 v17, v13, v13
    v_dot2c_f32_bf16 v16, v7, v14
    v_dot2c_f32_bf16 v17, v14, v14
    v_dot2c_f32_bf16 v16, v7, v15
    v_dot2c_f32_bf16 v17, v15, v15
    s_lshl_b32 s17, s17, 4
    s_add_u32 s17, s17, 229376
    v_add_f32_dpp v16, v16, v16 row_shr:1 row_mask:0xf bank_mask:0xf
    v_add_f32_dpp v17, v17, v17 row_shr:1 row_mask:0xf bank_mask:0xf
    s_nop 0
    v_add_f32_dpp v16, v16, v16 row_shr:2 row_mask:0xf bank_mask:0xf
    v_add_f32_dpp v17, v17, v17 row_shr:2 row_mask:0xf bank_mask:0xf
    s_nop 0
    v_add_f32_dpp v16, v16, v16 row_shr:4 row_mask:0xf bank_mask:0xf
    v_add_f32_dpp v17, v17, v17 row_shr:4 row_mask:0xf bank_mask:0xf
    s_nop 0
    v_add_f32_dpp v16, v16, v16 row_shr:8 row_mask:0xf bank_mask:0xf
    v_add_f32_dpp v17, v17, v17 row_shr:8 row_mask:0xf bank_mask:0xf
    s_nop 0
    v_add_f32_dpp v16, v16, v16 row_bcast:15 row_mask:0xa bank_mask:0xf
    v_add_f32_dpp v17, v17, v17 row_bcast:15 row_mask:0xa bank_mask:0xf
    s_nop 0
    v_add_f32_dpp v16, v16, v16 row_bcast:31 row_mask:0xc bank_mask:0xf
    v_add_f32_dpp v17, v17, v17 row_bcast:31 row_mask:0xc bank_mask:0xf
    v_mul_f32 v12, 0xbb124925, v16
    v_mul_f32 v17, 0x3b124925, v17
    v_fma_f32 v17, -v12, v12, v17
    v_max_f32 v17, 0, v17
    v_add_f32 v17, 0x3727c5ac, v17
    v_rsq_f32 v14, v17
    s_add_u32 m0, s72, 16384
    s_nop 0
    buffer_load_dwordx4 v52, s[20:23], s66 offen lds
    s_add_u32 m0, s72, 17408
    s_nop 0
    buffer_load_dwordx4 v53, s[20:23], s66 offen lds
    s_bfe_u32 s18, s81, 0x30008
    s_mul_i32 s66, s18, 128
    s_add_u32 s66, s66, s12
    s_add_u32 m0, s73, 73728
    s_nop 0
    buffer_load_dwordx4 v54, s[24:27], s67 offen lds
    s_mul_i32 s67, s18, 172032
    s_add_u32 s67, s67, s13
    s_add_u32 m0, s73, 106496
    s_nop 0
    buffer_load_dwordx4 v55, s[28:31], s68 offen lds
    s_mul_i32 s68, s18, s70
    s_add_u32 s68, s68, s14
    s_add_u32 m0, s73, 139264
    s_nop 0
    buffer_load_dwordx4 v56, s[32:35], s69 offen lds
    s_add_u32 s69, s68, s15
    s_waitcnt lgkmcnt(0)
    s_add_u32 s63, s63, 0x9e3779b9
    v_mov_b32 v13, s63
    v_mov_b32 v15, s63
    s_mov_b32 exec_lo, 0
    s_mov_b32 exec_hi, 0x80000000
    buffer_store_dwordx4 v[12:15], off, s[44:47], s17 sc1
    s_mov_b64 exec, -1
    s_waitcnt vmcnt(6)
    s_barrier
    ds_read_b128 v[128:131], v48 offset:0
    ds_read_b64_tr_b16 v[80:81], v60 offset:0
    ds_read_b64_tr_b16 v[82:83], v60 offset:512
    ds_read_b64_tr_b16 v[84:85], v64 offset:0
    ds_read_b64_tr_b16 v[86:87], v64 offset:512
    ds_read_b64_tr_b16 v[88:89], v68 offset:0
    ds_read_b64_tr_b16 v[90:91], v68 offset:512
    s_add_u32 m0, s72, 32768
    s_waitcnt lgkmcnt(4)
    v_mfma_f32_32x32x16_bf16 v[0:15], v[80:83], v[128:131], 0
    ds_read_b128 v[132:135], v49 offset:0
    ds_read_b64_tr_b16 v[92:93], v61 offset:0
    ds_read_b64_tr_b16 v[94:95], v61 offset:512
    buffer_load_dwordx4 v52, s[20:23], s66 offen lds
    v_lshlrev_b32 v244, 4, v245
    v_mfma_f32_16x16x32_bf16 v[116:119], v[112:115], v[80:83], 0
    s_add_u32 m0, s72, 33792
    s_waitcnt lgkmcnt(3)
    v_mfma_f32_32x32x16_bf16 v[16:31], v[84:87], v[128:131], 0
    ds_read_b64_tr_b16 v[96:97], v65 offset:0
    ds_read_b64_tr_b16 v[98:99], v65 offset:512
    ds_read_b64_tr_b16 v[100:101], v69 offset:0
    ds_read_b64_tr_b16 v[102:103], v69 offset:512
    buffer_load_dwordx4 v53, s[20:23], s66 offen lds
    s_bfe_u32 s18, s81, 0x3000c
    s_mul_i32 s66, s18, 128
    s_add_u32 s66, s66, s12
    s_lshl_b32 s82, s76, 9
    s_add_u32 s82, s82, 229376
    v_mfma_f32_32x32x16_bf16 v[32:47], v[88:91], v[128:131], 0
    v_and_b32 v57, 496, v244
    v_add_u32 v57, s82, v57
    s_add_u32 m0, s73, 81920
    s_waitcnt lgkmcnt(4)
    v_mfma_f32_32x32x16_bf16 v[0:15], v[92:95], v[132:135], v[0:15]
    ds_read_b128 v[136:139], v50 offset:0
    ds_read_b64_tr_b16 v[80:81], v62 offset:0
    ds_read_b64_tr_b16 v[82:83], v62 offset:512
    buffer_load_dwordx4 v54, s[24:27], s67 offen lds
    s_mul_i32 s67, s18, 172032
    s_add_u32 s67, s67, s13
    v_xor_b32 v108, 32, v104
    v_xor_b32 v105, 2048, v104
    s_add_u32 m0, s73, 114688
    s_waitcnt lgkmcnt(3)
    v_mfma_f32_32x32x16_bf16 v[16:31], v[96:99], v[132:135], v[16:31]
    ds_read_b64_tr_b16 v[84:85], v66 offset:0
    ds_read_b64_tr_b16 v[86:87], v66 offset:512
    ds_read_b64_tr_b16 v[88:89], v70 offset:0
    ds_read_b64_tr_b16 v[90:91], v70 offset:512
    buffer_load_dwordx4 v55, s[28:31], s68 offen lds
    s_mul_i32 s68, s18, s70
    s_add_u32 s68, s68, s14
    v_xor_b32 v106, 4096, v104
    v_mfma_f32_16x16x32_bf16 v[120:123], v[112:115], v[96:99], 0
    v_mfma_f32_32x32x16_bf16 v[32:47], v[100:103], v[132:135], v[32:47]
    v_xor_b32 v107, 6144, v104
    v_xor_b32 v109, 2048, v108
    s_add_u32 m0, s73, 147456
    s_waitcnt lgkmcnt(4)
    v_mfma_f32_32x32x16_bf16 v[0:15], v[80:83], v[136:139], v[0:15]
    ds_read_b128 v[140:143], v51 offset:0
    ds_read_b64_tr_b16 v[92:93], v63 offset:0
    ds_read_b64_tr_b16 v[94:95], v63 offset:512
    buffer_load_dwordx4 v56, s[32:35], s69 offen lds
    s_add_u32 s69, s68, s15
    v_xor_b32 v110, 4096, v108
    v_xor_b32 v111, 6144, v108
    s_waitcnt lgkmcnt(3)
    v_mfma_f32_32x32x16_bf16 v[16:31], v[84:87], v[136:139], v[16:31]
    ds_read_b64_tr_b16 v[96:97], v67 offset:0
    ds_read_b64_tr_b16 v[98:99], v67 offset:512
    ds_read_b64_tr_b16 v[100:101], v71 offset:0
    ds_read_b64_tr_b16 v[102:103], v71 offset:512
    v_mov_b32 v250, 0
    v_mov_b32 v251, 0
    s_add_u32 m0, s72, 49152
    v_mfma_f32_32x32x16_bf16 v[32:47], v[88:91], v[136:139], v[32:47]
    buffer_load_dwordx4 v52, s[20:23], s66 offen lds
    v_mov_b32 v254, 0
    v_mov_b32 v255, 0
    v_mfma_f32_16x16x32_bf16 v[124:127], v[112:115], v[88:91], 0
    s_waitcnt vmcnt(7)
    s_waitcnt lgkmcnt(0)
    s_barrier
    v_mfma_f32_32x32x16_bf16 v[0:15], v[92:95], v[140:143], v[0:15]
    ds_read_b128 v[144:147], v48 offset:16384
    ds_read_b64_tr_b16 v[80:81], v60 offset:8192
    ds_read_b64_tr_b16 v[82:83], v60 offset:8704
    s_mul_i32 s82, s77, 3072
    s_add_u32 m0, s72, 50176
    v_mfma_f32_32x32x16_bf16 v[16:31], v[96:99], v[140:143], v[16:31]
    ds_read_b64_tr_b16 v[84:85], v64 offset:8192
    ds_read_b64_tr_b16 v[86:87], v64 offset:8704
    ds_read_b64_tr_b16 v[88:89], v68 offset:8192
    ds_read_b64_tr_b16 v[90:91], v68 offset:8704
    buffer_load_dwordx4 v53, s[20:23], s66 offen lds
    s_bfe_u32 s18, s81, 0x30010
    s_mul_i32 s66, s18, 128
    s_add_u32 s66, s66, s12
    s_add_u32 s82, s82, 155648
    v_add_u32 v241, s82, v244
    v_mfma_f32_32x32x16_bf16 v[32:47], v[100:103], v[140:143], v[32:47]
    v_mov_b32 v76, -1
    v_mov_b32 v77, -1
    s_add_u32 m0, s73, 90112
    s_waitcnt lgkmcnt(4)
    v_mfma_f32_32x32x16_bf16 v[0:15], v[80:83], v[144:147], v[0:15]
    ds_read_b128 v[148:151], v49 offset:16384
    ds_read_b64_tr_b16 v[92:93], v61 offset:8192
    ds_read_b64_tr_b16 v[94:95], v61 offset:8704
    buffer_load_dwordx4 v54, s[24:27], s67 offen lds
    s_mul_i32 s67, s18, 172032
    s_add_u32 s67, s67, s13
    v_mov_b32 v78, -1
    v_mov_b32 v79, -1
    v_mfma_f32_16x16x32_bf16 v[116:119], v[112:115], v[80:83], v[116:119]
    s_waitcnt lgkmcnt(3)
    v_mfma_f32_32x32x16_bf16 v[16:31], v[84:87], v[144:147], v[16:31]
    ds_read_b64_tr_b16 v[96:97], v65 offset:8192
    ds_read_b64_tr_b16 v[98:99], v65 offset:8704
    ds_read_b64_tr_b16 v[100:101], v69 offset:8192
    ds_read_b64_tr_b16 v[102:103], v69 offset:8704
    s_lshl4_add_u32 s82, s76, s62
    s_add_u32 m0, s73, 122880
    v_mfma_f32_32x32x16_bf16 v[32:47], v[88:91], v[144:147], v[32:47]
    buffer_load_dwordx4 v55, s[28:31], s68 offen lds
    s_mul_i32 s68, s18, s70
    s_add_u32 s68, s68, s14
    s_lshl1_add_u32 s82, s82, s77
    s_lshl_b32 s82, s82, 10
    s_waitcnt lgkmcnt(4)
    v_mfma_f32_32x32x16_bf16 v[0:15], v[92:95], v[148:151], v[0:15]
    ds_read_b128 v[152:155], v50 offset:16384
    ds_read_b64_tr_b16 v[80:81], v62 offset:8192
    ds_read_b64_tr_b16 v[82:83], v62 offset:8704
    s_add_u32 s82, s82, 6815744
    v_bfe_u32 v73, v245, 1, 1
    s_add_u32 m0, s73, 155648
    s_waitcnt lgkmcnt(3)
    v_mfma_f32_32x32x16_bf16 v[16:31], v[96:99], v[148:151], v[16:31]
    ds_read_b64_tr_b16 v[84:85], v66 offset:8192
    ds_read_b64_tr_b16 v[86:87], v66 offset:8704
    ds_read_b64_tr_b16 v[88:89], v70 offset:8192
    ds_read_b64_tr_b16 v[90:91], v70 offset:8704
    buffer_load_dwordx4 v56, s[32:35], s69 offen lds
    s_add_u32 s69, s68, s15
    v_and_b32 v72, 1, v245
    v_or_b32 v72, v72, v73
    v_mfma_f32_16x16x32_bf16 v[120:123], v[112:115], v[96:99], v[120:123]
    v_mfma_f32_32x32x16_bf16 v[32:47], v[100:103], v[148:151], v[32:47]
    v_add_u32 v72, -1, v72
    v_and_b32 v72, 0x3f803f80, v72
    s_add_u32 m0, s72, 0
    s_waitcnt lgkmcnt(4)
    v_mfma_f32_32x32x16_bf16 v[0:15], v[80:83], v[152:155], v[0:15]
    ds_read_b128 v[156:159], v51 offset:16384
    ds_read_b64_tr_b16 v[92:93], v63 offset:8192
    ds_read_b64_tr_b16 v[94:95], v63 offset:8704
    buffer_load_dwordx4 v52, s[20:23], s66 offen lds
    s_lshl_b32 s83, s62, 6
    s_waitcnt lgkmcnt(3)
    v_mfma_f32_32x32x16_bf16 v[16:31], v[84:87], v[152:155], v[16:31]
    ds_read_b64_tr_b16 v[96:97], v67 offset:8192
    ds_read_b64_tr_b16 v[98:99], v67 offset:8704
    ds_read_b64_tr_b16 v[100:101], v71 offset:8192
    ds_read_b64_tr_b16 v[102:103], v71 offset:8704
    s_add_u32 s83, s83, s76
    s_lshl1_add_u32 s83, s83, s77
    s_add_u32 m0, s72, 1024
    v_mfma_f32_32x32x16_bf16 v[32:47], v[88:91], v[152:155], v[32:47]
    buffer_load_dwordx4 v53, s[20:23], s66 offen lds
    s_bfe_u32 s18, s81, 0x30014
    s_mul_i32 s66, s18, 128
    s_add_u32 s66, s66, s12
    s_lshl_b32 s83, s83, 10
    s_add_u32 s83, s83, 4718592
    v_mfma_f32_16x16x32_bf16 v[124:127], v[112:115], v[88:91], v[124:127]
    s_waitcnt vmcnt(7)
    s_waitcnt lgkmcnt(0)
    s_barrier
    v_mfma_f32_32x32x16_bf16 v[0:15], v[92:95], v[156:159], v[0:15]
    ds_read_b128 v[160:163], v48 offset:32768
    ds_read_b64_tr_b16 v[80:81], v60 offset:16384
    ds_read_b64_tr_b16 v[82:83], v60 offset:16896
    v_mov_b32 v73, v72
    v_mov_b32 v74, v72
    s_add_u32 m0, s73, 65536
    v_mfma_f32_32x32x16_bf16 v[16:31], v[96:99], v[156:159], v[16:31]
    ds_read_b64_tr_b16 v[84:85], v64 offset:16384
    ds_read_b64_tr_b16 v[86:87], v64 offset:16896
    ds_read_b64_tr_b16 v[88:89], v68 offset:16384
    ds_read_b64_tr_b16 v[90:91], v68 offset:16896
    buffer_load_dwordx4 v54, s[24:27], s67 offen lds
    s_mul_i32 s67, s18, 172032
    s_add_u32 s67, s67, s13
    v_mov_b32 v75, v72
    v_mfma_f32_32x32x16_bf16 v[32:47], v[100:103], v[156:159], v[32:47]
    buffer_store_dwordx4 v[76:79], v244, s[44:47], s82 offen offset:0 sc1
    s_mov_b32 exec_lo, 0xf0000000
    s_mov_b32 exec_hi, 0xf0000000
    buffer_store_dwordx4 v[72:75], v244, s[44:47], s83 offen offset:0 sc1
    s_mov_b64 exec, -1
    s_add_u32 m0, s73, 98304
    s_waitcnt lgkmcnt(4)
    v_mfma_f32_32x32x16_bf16 v[0:15], v[80:83], v[160:163], v[0:15]
    ds_read_b128 v[164:167], v49 offset:32768
    ds_read_b64_tr_b16 v[92:93], v61 offset:16384
    ds_read_b64_tr_b16 v[94:95], v61 offset:16896
    buffer_load_dwordx4 v55, s[28:31], s68 offen lds
    s_mul_i32 s68, s18, s70
    s_add_u32 s68, s68, s14
    s_cmp_lt_u32 s75, 7
    s_cselect_b32 s80, 0x3e8b97f6, 1.0
    s_lshl1_add_u32 s82, s75, s77
    v_mfma_f32_16x16x32_bf16 v[116:119], v[112:115], v[80:83], v[116:119]
    s_waitcnt lgkmcnt(3)
    v_mfma_f32_32x32x16_bf16 v[16:31], v[84:87], v[160:163], v[16:31]
    ds_read_b64_tr_b16 v[96:97], v65 offset:16384
    ds_read_b64_tr_b16 v[98:99], v65 offset:16896
    ds_read_b64_tr_b16 v[100:101], v69 offset:16384
    ds_read_b64_tr_b16 v[102:103], v69 offset:16896
    s_lshl_b32 s82, s82, 11
    s_mul_i32 s83, s76, 57344
    s_add_u32 m0, s73, 131072
    v_mfma_f32_32x32x16_bf16 v[32:47], v[88:91], v[160:163], v[32:47]
    buffer_load_dwordx4 v56, s[32:35], s69 offen lds
    s_add_u32 s69, s68, s15
    s_add_u32 s83, s83, s82
    s_add_u32 s4, s83, 1048576
    s_waitcnt lgkmcnt(4)
    v_mfma_f32_32x32x16_bf16 v[0:15], v[92:95], v[164:167], v[0:15]
    ds_read_b128 v[168:171], v50 offset:32768
    ds_read_b64_tr_b16 v[80:81], v62 offset:16384
    ds_read_b64_tr_b16 v[82:83], v62 offset:16896
    s_add_u32 s5, s83, 1052672
    s_add_u32 m0, s72, 16384
    s_waitcnt lgkmcnt(3)
    v_mfma_f32_32x32x16_bf16 v[16:31], v[96:99], v[164:167], v[16:31]
    ds_read_b64_tr_b16 v[84:85], v66 offset:16384
    ds_read_b64_tr_b16 v[86:87], v66 offset:16896
    ds_read_b64_tr_b16 v[88:89], v70 offset:16384
    ds_read_b64_tr_b16 v[90:91], v70 offset:16896
    buffer_load_dwordx4 v52, s[20:23], s66 offen lds
    s_add_u32 s6, s83, 1056768
    s_mul_i32 s83, s76, 28
    v_mfma_f32_16x16x32_bf16 v[120:123], v[112:115], v[96:99], v[120:123]
    v_mfma_f32_32x32x16_bf16 v[32:47], v[100:103], v[164:167], v[32:47]
    s_add_u32 s83, s83, s62
    s_lshl1_add_u32 s83, s83, s77
    s_add_u32 m0, s72, 17408
    s_waitcnt lgkmcnt(4)
    v_mfma_f32_32x32x16_bf16 v[0:15], v[80:83], v[168:171], v[0:15]
    ds_read_b128 v[172:175], v51 offset:32768
    ds_read_b64_tr_b16 v[92:93], v63 offset:16384
    ds_read_b64_tr_b16 v[94:95], v63 offset:16896
    buffer_load_dwordx4 v53, s[20:23], s66 offen lds
    s_bfe_u32 s18, s81, 0x30018
    s_mul_i32 s66, s18, 128
    s_add_u32 s66, s66, s12
    s_lshl_b32 s83, s83, 11
    s_add_u32 s8, s83, 8912896
    s_waitcnt lgkmcnt(3)
    v_mfma_f32_32x32x16_bf16 v[16:31], v[84:87], v[168:171], v[16:31]
    ds_read_b64_tr_b16 v[96:97], v67 offset:16384
    ds_read_b64_tr_b16 v[98:99], v67 offset:16896
    ds_read_b64_tr_b16 v[100:101], v71 offset:16384
    ds_read_b64_tr_b16 v[102:103], v71 offset:16896
    s_add_u32 s7, s8, 49152
    s_add_u32 m0, s73, 73728
    v_mfma_f32_32x32x16_bf16 v[32:47], v[88:91], v[168:171], v[32:47]
    buffer_load_dwordx4 v54, s[24:27], s67 offen lds
    s_mul_i32 s67, s18, 172032
    s_add_u32 s67, s67, s13
    s_lshl4_add_u32 s82, s61, s62
    s_lshl_b32 s83, s82, 7
    v_mfma_f32_16x16x32_bf16 v[124:127], v[112:115], v[88:91], v[124:127]
    s_waitcnt vmcnt(10)
    s_waitcnt lgkmcnt(0)
    s_barrier
    v_mfma_f32_32x32x16_bf16 v[0:15], v[92:95], v[172:175], v[0:15]
    ds_read_b128 v[176:179], v48 offset:49152
    ds_read_b64_tr_b16 v[80:81], v60 offset:24576
    ds_read_b64_tr_b16 v[82:83], v60 offset:25088
    s_add_u32 s9, s83, 4096
    s_add_u32 s11, s83, 36864
    s_add_u32 m0, s73, 106496
    v_mfma_f32_32x32x16_bf16 v[16:31], v[96:99], v[172:175], v[16:31]
    ds_read_b64_tr_b16 v[84:85], v64 offset:24576
    ds_read_b64_tr_b16 v[86:87], v64 offset:25088
    ds_read_b64_tr_b16 v[88:89], v68 offset:24576
    ds_read_b64_tr_b16 v[90:91], v68 offset:25088
    buffer_load_dwordx4 v55, s[28:31], s68 offen lds
    s_mul_i32 s68, s18, s70
    s_add_u32 s68, s68, s14
    s_lshl3_add_u32 s82, s82, s60
    s_lshl_b32 s82, s82, 7
    v_mfma_f32_32x32x16_bf16 v[32:47], v[100:103], v[172:175], v[32:47]
    s_add_u32 s10, s82, 262144
    v_mov_b32 v246, s63
    s_add_u32 m0, s73, 139264
    s_waitcnt lgkmcnt(4)
    v_mfma_f32_32x32x16_bf16 v[0:15], v[80:83], v[176:179], v[0:15]
    ds_read_b128 v[180:183], v49 offset:49152
    ds_read_b64_tr_b16 v[92:93], v61 offset:24576
    ds_read_b64_tr_b16 v[94:95], v61 offset:25088
    buffer_load_dwordx4 v56, s[32:35], s69 offen lds
    s_add_u32 s69, s68, s15
    v_mfma_f32_16x16x32_bf16 v[116:119], v[112:115], v[80:83], v[116:119]
    s_waitcnt lgkmcnt(3)
    v_mfma_f32_32x32x16_bf16 v[16:31], v[84:87], v[176:179], v[16:31]
    ds_read_b64_tr_b16 v[96:97], v65 offset:24576
    ds_read_b64_tr_b16 v[98:99], v65 offset:25088
    ds_read_b64_tr_b16 v[100:101], v69 offset:24576
    ds_read_b64_tr_b16 v[102:103], v69 offset:25088
    s_add_u32 m0, s72, 32768
    v_mfma_f32_32x32x16_bf16 v[32:47], v[88:91], v[176:179], v[32:47]
    buffer_load_dwordx4 v52, s[20:23], s66 offen lds
    s_waitcnt lgkmcnt(4)
    v_mfma_f32_32x32x16_bf16 v[0:15], v[92:95], v[180:183], v[0:15]
    ds_read_b128 v[184:187], v50 offset:49152
    ds_read_b64_tr_b16 v[80:81], v62 offset:24576
    ds_read_b64_tr_b16 v[82:83], v62 offset:25088
    s_add_u32 m0, s72, 33792
    s_waitcnt lgkmcnt(3)
    v_mfma_f32_32x32x16_bf16 v[16:31], v[96:99], v[180:183], v[16:31]
    ds_read_b64_tr_b16 v[84:85], v66 offset:24576
    ds_read_b64_tr_b16 v[86:87], v66 offset:25088
    ds_read_b64_tr_b16 v[88:89], v70 offset:24576
    ds_read_b64_tr_b16 v[90:91], v70 offset:25088
    buffer_load_dwordx4 v53, s[20:23], s66 offen lds
    v_mfma_f32_16x16x32_bf16 v[120:123], v[112:115], v[96:99], v[120:123]
    v_mfma_f32_32x32x16_bf16 v[32:47], v[100:103], v[180:183], v[32:47]
    s_add_u32 m0, s73, 81920
    s_waitcnt lgkmcnt(4)
    v_mfma_f32_32x32x16_bf16 v[0:15], v[80:83], v[184:187], v[0:15]
    ds_read_b128 v[188:191], v51 offset:49152
    ds_read_b64_tr_b16 v[92:93], v63 offset:24576
    ds_read_b64_tr_b16 v[94:95], v63 offset:25088
    buffer_load_dwordx4 v54, s[24:27], s67 offen lds
    s_waitcnt lgkmcnt(3)
    v_mfma_f32_32x32x16_bf16 v[16:31], v[84:87], v[184:187], v[16:31]
    ds_read_b64_tr_b16 v[96:97], v67 offset:24576
    ds_read_b64_tr_b16 v[98:99], v67 offset:25088
    ds_read_b64_tr_b16 v[100:101], v71 offset:24576
    ds_read_b64_tr_b16 v[102:103], v71 offset:25088
    s_add_u32 m0, s73, 114688
    v_mfma_f32_32x32x16_bf16 v[32:47], v[88:91], v[184:187], v[32:47]
    buffer_load_dwordx4 v55, s[28:31], s68 offen lds
    v_mfma_f32_16x16x32_bf16 v[124:127], v[112:115], v[88:91], v[124:127]
    s_waitcnt vmcnt(9)
    s_waitcnt lgkmcnt(0)
    s_barrier
    v_mfma_f32_32x32x16_bf16 v[0:15], v[92:95], v[188:191], v[0:15]
    ds_read_b128 v[192:195], v48 offset:0
    ds_read_b64_tr_b16 v[80:81], v60 offset:0
    ds_read_b64_tr_b16 v[82:83], v60 offset:512
    s_add_u32 m0, s73, 147456
    v_mfma_f32_32x32x16_bf16 v[16:31], v[96:99], v[188:191], v[16:31]
    ds_read_b64_tr_b16 v[84:85], v64 offset:0
    ds_read_b64_tr_b16 v[86:87], v64 offset:512
    ds_read_b64_tr_b16 v[88:89], v68 offset:0
    ds_read_b64_tr_b16 v[90:91], v68 offset:512
    buffer_load_dwordx4 v56, s[32:35], s69 offen lds
    v_mfma_f32_32x32x16_bf16 v[32:47], v[100:103], v[188:191], v[32:47]
    s_add_u32 m0, s73, 49152
    s_waitcnt lgkmcnt(4)
    v_mfma_f32_32x32x16_bf16 v[0:15], v[80:83], v[192:195], v[0:15]
    ds_read_b128 v[196:199], v49 offset:0
    ds_read_b64_tr_b16 v[92:93], v61 offset:0
    ds_read_b64_tr_b16 v[94:95], v61 offset:512
    buffer_load_dwordx4 v242, s[36:39], s71 offen lds
    v_mfma_f32_16x16x32_bf16 v[116:119], v[112:115], v[80:83], v[116:119]
    s_waitcnt lgkmcnt(3)
    v_mfma_f32_32x32x16_bf16 v[16:31], v[84:87], v[192:195], v[16:31]
    ds_read_b64_tr_b16 v[96:97], v65 offset:0
    ds_read_b64_tr_b16 v[98:99], v65 offset:512
    ds_read_b64_tr_b16 v[100:101], v69 offset:0
    ds_read_b64_tr_b16 v[102:103], v69 offset:512
    s_add_u32 m0, s73, 57344
    v_mfma_f32_32x32x16_bf16 v[32:47], v[88:91], v[192:195], v[32:47]
    buffer_load_dwordx4 v243, s[40:43], s71 offen lds
    s_bfe_u32 s18, s81, 0x30004
    s_mul_i32 s71, s18, 229376
    s_add_u32 s71, s71, s16
    s_waitcnt lgkmcnt(4)
    v_mfma_f32_32x32x16_bf16 v[0:15], v[92:95], v[196:199], v[0:15]
    ds_read_b128 v[200:203], v50 offset:0
    ds_read_b64_tr_b16 v[80:81], v62 offset:0
    ds_read_b64_tr_b16 v[82:83], v62 offset:512
    s_waitcnt lgkmcnt(3)
    v_mfma_f32_32x32x16_bf16 v[16:31], v[96:99], v[196:199], v[16:31]
    ds_read_b64_tr_b16 v[84:85], v66 offset:0
    ds_read_b64_tr_b16 v[86:87], v66 offset:512
    ds_read_b64_tr_b16 v[88:89], v70 offset:0
    ds_read_b64_tr_b16 v[90:91], v70 offset:512
    v_mfma_f32_16x16x32_bf16 v[120:123], v[112:115], v[96:99], v[120:123]
    v_mfma_f32_32x32x16_bf16 v[32:47], v[100:103], v[196:199], v[32:47]
    s_waitcnt lgkmcnt(4)
    v_mfma_f32_32x32x16_bf16 v[0:15], v[80:83], v[200:203], v[0:15]
    ds_read_b128 v[204:207], v51 offset:0
    ds_read_b64_tr_b16 v[92:93], v63 offset:0
    ds_read_b64_tr_b16 v[94:95], v63 offset:512
    s_waitcnt lgkmcnt(3)
    v_mfma_f32_32x32x16_bf16 v[16:31], v[84:87], v[200:203], v[16:31]
    ds_read_b64_tr_b16 v[96:97], v67 offset:0
    ds_read_b64_tr_b16 v[98:99], v67 offset:512
    ds_read_b64_tr_b16 v[100:101], v71 offset:0
    ds_read_b64_tr_b16 v[102:103], v71 offset:512
    v_mfma_f32_32x32x16_bf16 v[32:47], v[88:91], v[200:203], v[32:47]
    v_mfma_f32_16x16x32_bf16 v[124:127], v[112:115], v[88:91], v[124:127]
    s_waitcnt vmcnt(7)
    s_waitcnt lgkmcnt(0)
    s_barrier
    v_mfma_f32_32x32x16_bf16 v[0:15], v[92:95], v[204:207], v[0:15]
    ds_read_b128 v[208:211], v48 offset:16384
    ds_read_b64_tr_b16 v[80:81], v60 offset:8192
    ds_read_b64_tr_b16 v[82:83], v60 offset:8704
    s_add_u32 m0, s73, 0
    v_mfma_f32_32x32x16_bf16 v[16:31], v[96:99], v[204:207], v[16:31]
    ds_read_b64_tr_b16 v[84:85], v64 offset:8192
    ds_read_b64_tr_b16 v[86:87], v64 offset:8704
    ds_read_b64_tr_b16 v[88:89], v68 offset:8192
    ds_read_b64_tr_b16 v[90:91], v68 offset:8704
    buffer_load_dwordx4 v242, s[36:39], s71 offen lds
    s_add_u32 m0, s73, 8192
    v_mfma_f32_32x32x16_bf16 v[32:47], v[100:103], v[204:207], v[32:47]
    buffer_load_dwordx4 v243, s[40:43], s71 offen lds
    s_bfe_u32 s18, s81, 0x30008
    s_mul_i32 s71, s18, 229376
    s_add_u32 s71, s71, s16
    s_waitcnt lgkmcnt(4)
    v_mfma_f32_32x32x16_bf16 v[0:15], v[80:83], v[208:211], v[0:15]
    ds_read_b128 v[212:215], v49 offset:16384
    ds_read_b64_tr_b16 v[92:93], v61 offset:8192
    ds_read_b64_tr_b16 v[94:95], v61 offset:8704
    v_mfma_f32_16x16x32_bf16 v[116:119], v[112:115], v[80:83], v[116:119]
    s_add_u32 m0, s73, 90112
    s_waitcnt lgkmcnt(3)
    v_mfma_f32_32x32x16_bf16 v[16:31], v[84:87], v[208:211], v[16:31]
    ds_read_b64_tr_b16 v[96:97], v65 offset:8192
    ds_read_b64_tr_b16 v[98:99], v65 offset:8704
    ds_read_b64_tr_b16 v[100:101], v69 offset:8192
    ds_read_b64_tr_b16 v[102:103], v69 offset:8704
    buffer_load_dwordx4 v242, s[36:39], s71 offen lds
    v_mfma_f32_32x32x16_bf16 v[32:47], v[88:91], v[208:211], v[32:47]
    s_add_u32 m0, s73, 98304
    s_waitcnt lgkmcnt(4)
    v_mfma_f32_32x32x16_bf16 v[0:15], v[92:95], v[212:215], v[0:15]
    ds_read_b128 v[216:219], v50 offset:16384
    ds_read_b64_tr_b16 v[80:81], v62 offset:8192
    ds_read_b64_tr_b16 v[82:83], v62 offset:8704
    buffer_load_dwordx4 v243, s[40:43], s71 offen lds
    s_bfe_u32 s18, s81, 0x3000c
    s_mul_i32 s71, s18, 229376
    s_add_u32 s71, s71, s16
    s_waitcnt lgkmcnt(3)
    v_mfma_f32_32x32x16_bf16 v[16:31], v[96:99], v[212:215], v[16:31]
    ds_read_b64_tr_b16 v[84:85], v66 offset:8192
    ds_read_b64_tr_b16 v[86:87], v66 offset:8704
    ds_read_b64_tr_b16 v[88:89], v70 offset:8192
    ds_read_b64_tr_b16 v[90:91], v70 offset:8704
    v_mfma_f32_16x16x32_bf16 v[120:123], v[112:115], v[96:99], v[120:123]
    s_add_u32 m0, s73, 122880
    v_mfma_f32_32x32x16_bf16 v[32:47], v[100:103], v[212:215], v[32:47]
    buffer_load_dwordx4 v242, s[36:39], s71 offen lds
    s_add_u32 m0, s73, 131072
    s_waitcnt lgkmcnt(4)
    v_mfma_f32_32x32x16_bf16 v[0:15], v[80:83], v[216:219], v[0:15]
    ds_read_b128 v[220:223], v51 offset:16384
    ds_read_b64_tr_b16 v[92:93], v63 offset:8192
    ds_read_b64_tr_b16 v[94:95], v63 offset:8704
    buffer_load_dwordx4 v243, s[40:43], s71 offen lds
    s_bfe_u32 s18, s81, 0x30010
    s_mul_i32 s71, s18, 229376
    s_add_u32 s71, s71, s16
    s_waitcnt lgkmcnt(3)
    v_mfma_f32_32x32x16_bf16 v[16:31], v[84:87], v[216:219], v[16:31]
    ds_read_b64_tr_b16 v[96:97], v67 offset:8192
    ds_read_b64_tr_b16 v[98:99], v67 offset:8704
    ds_read_b64_tr_b16 v[100:101], v71 offset:8192
    ds_read_b64_tr_b16 v[102:103], v71 offset:8704
    v_mfma_f32_32x32x16_bf16 v[32:47], v[88:91], v[216:219], v[32:47]
    v_mfma_f32_16x16x32_bf16 v[124:127], v[112:115], v[88:91], v[124:127]
    s_waitcnt vmcnt(8)
    s_waitcnt lgkmcnt(0)
    s_barrier
    v_mfma_f32_32x32x16_bf16 v[0:15], v[92:95], v[220:223], v[0:15]
    ds_read_b128 v[224:227], v48 offset:32768
    ds_read_b64_tr_b16 v[80:81], v60 offset:16384
    ds_read_b64_tr_b16 v[82:83], v60 offset:16896
    s_add_u32 m0, s73, 16384
    v_mfma_f32_32x32x16_bf16 v[16:31], v[96:99], v[220:223], v[16:31]
    ds_read_b64_tr_b16 v[84:85], v64 offset:16384
    ds_read_b64_tr_b16 v[86:87], v64 offset:16896
    ds_read_b64_tr_b16 v[88:89], v68 offset:16384
    ds_read_b64_tr_b16 v[90:91], v68 offset:16896
    buffer_load_dwordx4 v242, s[36:39], s71 offen lds
    s_lshl_b32 s82, s79, 2
    v_add_u32 v58, s82, v241
    s_add_u32 m0, s73, 24576
    v_mfma_f32_32x32x16_bf16 v[32:47], v[100:103], v[220:223], v[32:47]
    buffer_load_dwordx4 v243, s[40:43], s71 offen lds
    s_bfe_u32 s18, s81, 0x30014
    s_mul_i32 s71, s18, 229376
    s_add_u32 s71, s71, s16
    s_waitcnt lgkmcnt(4)
    v_mfma_f32_32x32x16_bf16 v[0:15], v[80:83], v[224:227], v[0:15]
    ds_read_b128 v[228:231], v49 offset:32768
    ds_read_b64_tr_b16 v[92:93], v61 offset:16384
    ds_read_b64_tr_b16 v[94:95], v61 offset:16896
    v_mfma_f32_16x16x32_bf16 v[116:119], v[112:115], v[80:83], v[116:119]
    s_add_u32 m0, s73, 65536
    s_waitcnt lgkmcnt(3)
    v_mfma_f32_32x32x16_bf16 v[16:31], v[84:87], v[224:227], v[16:31]
    ds_read_b64_tr_b16 v[96:97], v65 offset:16384
    ds_read_b64_tr_b16 v[98:99], v65 offset:16896
    ds_read_b64_tr_b16 v[100:101], v69 offset:16384
    ds_read_b64_tr_b16 v[102:103], v69 offset:16896
    buffer_load_dwordx4 v242, s[36:39], s71 offen lds
    v_mfma_f32_16x16x32_bf16 v[120:123], v[112:115], v[84:87], v[120:123]
    v_mfma_f32_32x32x16_bf16 v[32:47], v[88:91], v[224:227], v[32:47]
    buffer_load_dwordx4 v[72:75], v57, s[44:47], 0 offen sc1
    v_mfma_f32_16x16x32_bf16 v[124:127], v[112:115], v[88:91], v[124:127]
    s_add_u32 m0, s73, 73728
    s_waitcnt lgkmcnt(4)
    v_mfma_f32_32x32x16_bf16 v[0:15], v[92:95], v[228:231], v[0:15]
    ds_read_b128 v[232:235], v50 offset:32768
    ds_read_b64_tr_b16 v[80:81], v62 offset:16384
    ds_read_b64_tr_b16 v[82:83], v62 offset:16896
    buffer_load_dwordx4 v243, s[40:43], s71 offen lds
    s_bfe_u32 s18, s81, 0x30018
    s_mul_i32 s71, s18, 229376
    s_add_u32 s71, s71, s16
    s_waitcnt lgkmcnt(3)
    v_mfma_f32_32x32x16_bf16 v[16:31], v[96:99], v[228:231], v[16:31]
    ds_read_b64_tr_b16 v[84:85], v66 offset:16384
    ds_read_b64_tr_b16 v[86:87], v66 offset:16896
    ds_read_b64_tr_b16 v[88:89], v70 offset:16384
    ds_read_b64_tr_b16 v[90:91], v70 offset:16896
    v_mfma_f32_32x32x16_bf16 v[32:47], v[100:103], v[228:231], v[32:47]
    s_waitcnt lgkmcnt(4)
    v_mfma_f32_32x32x16_bf16 v[0:15], v[80:83], v[232:235], v[0:15]
    ds_read_b128 v[236:239], v51 offset:32768
    ds_read_b64_tr_b16 v[92:93], v63 offset:16384
    ds_read_b64_tr_b16 v[94:95], v63 offset:16896
    s_waitcnt lgkmcnt(3)
    v_mfma_f32_32x32x16_bf16 v[16:31], v[84:87], v[232:235], v[16:31]
    ds_read_b64_tr_b16 v[96:97], v67 offset:16384
    ds_read_b64_tr_b16 v[98:99], v67 offset:16896
    ds_read_b64_tr_b16 v[100:101], v71 offset:16384
    ds_read_b64_tr_b16 v[102:103], v71 offset:16896
    s_waitcnt vmcnt(1)
    v_cmp_ne_u32 vcc, s63, v73
    v_cmp_ne_u32 s[84:85], s63, v75
    s_nop 2
    s_or_b64 vcc, vcc, s[84:85]
    s_cbranch_vccz L_staok
    s_mov_b32 s87, 0
L_sta:
    buffer_load_dwordx4 v[72:75], v57, s[44:47], 0 offen sc1
    s_add_u32 s87, s87, 1
    s_waitcnt vmcnt(0)
    v_cmp_ne_u32 vcc, s63, v73
    v_cmp_ne_u32 s[84:85], s63, v75
    s_nop 2
    s_or_b64 vcc, vcc, s[84:85]
    s_cmp_lt_u32 s87, 100000
    s_cselect_b64 s[84:85], -1, 0
    s_and_b64 vcc, vcc, s[84:85]
    s_cbranch_vccnz L_sta
L_staok:
    v_and_b32 v76, s74, v72
    v_mul_f32 v240, v74, v74
    v_sub_f32 v77, v72, v76
    v_cvt_pk_bf16_f32 v248, v76, v76
    v_mul_f32 v247, s80, v74
    v_cvt_pk_bf16_f32 v249, v77, v250
    v_mfma_f32_32x32x16_bf16 v[32:47], v[88:91], v[232:235], v[32:47]
    ds_write_b32 v58, v124 offset:2048
    ds_write_b32 v58, v120 offset:1024
    ds_write_b32 v58, v116 offset:0
    s_waitcnt lgkmcnt(7)
    v_mfma_f32_32x32x16_bf16 v[0:15], v[92:95], v[236:239], v[0:15]
    s_waitcnt lgkmcnt(0)
    s_barrier
    ds_read_b128 v[116:119], v241 offset:0
    ds_read_b128 v[120:123], v241 offset:1024
    ds_read_b128 v[124:127], v241 offset:2048
    v_mfma_f32_32x32x16_bf16 v[16:31], v[96:99], v[236:239], v[16:31]
    ds_read_b64_tr_b16 v[80:81], v104 offset:49152
    ds_read_b64_tr_b16 v[82:83], v104 offset:49664
    ds_read_b64_tr_b16 v[84:85], v108 offset:49152
    ds_read_b64_tr_b16 v[86:87], v108 offset:49664
    v_mfma_f32_32x32x16_bf16 v[32:47], v[100:103], v[236:239], v[32:47]
    s_waitcnt lgkmcnt(6)
    v_add_f32 v116, v116, v117
    v_add_f32 v118, v118, v119
    v_add_f32 v116, v116, v118
    v_and_b32 v117, s74, v116
    v_lshrrev_b32 v253, 16, v116
    v_sub_f32 v118, v116, v117
    v_cvt_pk_bf16_f32 v252, v117, v118
    s_nop 1
    v_mfma_f32_32x32x16_bf16 v[0:15], v[252:255], v[248:251], v[0:15]
    s_waitcnt lgkmcnt(5)
    v_add_f32 v120, v120, v121
    v_add_f32 v122, v122, v123
    v_add_f32 v120, v120, v122
    v_and_b32 v121, s74, v120
    v_lshrrev_b32 v253, 16, v120
    v_sub_f32 v122, v120, v121
    v_cvt_pk_bf16_f32 v252, v121, v122
    s_nop 1
    v_mfma_f32_32x32x16_bf16 v[16:31], v[252:255], v[248:251], v[16:31]
    s_waitcnt lgkmcnt(4)
    v_add_f32 v124, v124, v125
    v_add_f32 v126, v126, v127
    v_add_f32 v124, v124, v126
    v_and_b32 v125, s74, v124
    v_lshrrev_b32 v253, 16, v124
    v_sub_f32 v126, v124, v125
    v_cvt_pk_bf16_f32 v252, v125, v126
    s_nop 1
    v_mfma_f32_32x32x16_bf16 v[32:47], v[252:255], v[248:251], v[32:47]
    s_cmp_eq_u32 s78, 2
    s_cbranch_scc0 L_vaa
    v_lshrrev_b32 v89, 5, v245
    v_bfe_u32 v90, v245, 1, 2
    v_xor_b32 v90, v89, v90
    v_and_b32 v91, 31, v245
    v_lshl_add_u32 v88, v91, 2, v90
    v_lshl_add_u32 v88, v88, 4, s72
    s_lshl1_add_u32 s82, s75, s77
    s_lshl_b32 s82, s82, 5
    s_sub_u32 s82, s82, 896
    v_add_u32 v91, s82, v91
    v_mul_u32_u24 v90, 2341, v91
    v_lshrrev_b32 v90, 16, v90
    v_mul_u32_u24 v90, 8164, v90
    v_add_u32 v91, v91, v90
    v_lshl_add_u32 v91, v89, 5, v91
    v_lshlrev_b32 v91, 4, v91
    s_lshl_b32 s82, s76, 11
    s_add_u32 s4, s82, 4718592
    v_bfe_u32 v90, v245, 2, 2
    v_lshl_add_u32 v90, v89, 2, v90
    v_lshrrev_b32 v89, 2, v245
    v_and_b32 v89, 4, v89
    v_and_or_b32 v89, v245, 3, v89
    v_and_b32 v252, 6, v90
    v_xor_b32 v89, v89, v252
    v_lshl_add_u32 v90, v90, 3, v89
    v_lshl_add_u32 v90, v90, 3, s72
    v_xor_b32 v89, 32, v88
L_vaa:
    s_cmp_ge_u32 s60, 4
    s_cbranch_scc1 L_passA1
    s_setprio 0
    s_cmp_eq_u32 s78, 2
    s_cbranch_scc1 L_epiVa
    s_cmp_eq_u32 s78, 3
    s_cbranch_scc1 L_epiGa
    v_mul_f32 v0, v247, v0
    v_mul_f32 v1, v247, v1
    v_mul_f32 v2, v247, v2
    v_mul_f32 v3, v247, v3
    v_mul_f32 v4, v247, v4
    v_mul_f32 v5, v247, v5
    v_mul_f32 v6, v247, v6
    v_mul_f32 v7, v247, v7
    v_cvt_pk_bf16_f32 v0, v0, v1
    v_cvt_pk_bf16_f32 v1, v2, v3
    v_cvt_pk_bf16_f32 v2, v4, v5
    v_cvt_pk_bf16_f32 v3, v6, v7
    buffer_store_dwordx4 v[0:3], v244, s[44:47], s4 offen offset:0 sc1
    v_mul_f32 v8, v247, v8
    v_mul_f32 v9, v247, v9
    v_mul_f32 v10, v247, v10
    v_mul_f32 v11, v247, v11
    v_mul_f32 v12, v247, v12
    v_mul_f32 v13, v247, v13
    v_mul_f32 v14, v247, v14
    v_mul_f32 v15, v247, v15
    v_cvt_pk_bf16_f32 v4, v8, v9
    v_cvt_pk_bf16_f32 v5, v10, v11
    v_cvt_pk_bf16_f32 v6, v12, v13
    v_cvt_pk_bf16_f32 v7, v14, v15
    buffer_store_dwordx4 v[4:7], v244, s[44:47], s4 offen offset:1024 sc1
    s_cmp_eq_u32 s78, 0
    s_cbranch_scc0 L_epiGa
    v_mul_f32 v16, v247, v16
    v_mul_f32 v17, v247, v17
    v_mul_f32 v18, v247, v18
    v_mul_f32 v19, v247, v19
    v_mul_f32 v20, v247, v20
    v_mul_f32 v21, v247, v21
    v_mul_f32 v22, v247, v22
    v_mul_f32 v23, v247, v23
    v_cvt_pk_bf16_f32 v16, v16, v17
    v_cvt_pk_bf16_f32 v17, v18, v19
    v_cvt_pk_bf16_f32 v18, v20, v21
    v_cvt_pk_bf16_f32 v19, v22, v23
    buffer_store_dwordx4 v[16:19], v244, s[44:47], s5 offen offset:0 sc1
    v_mul_f32 v24, v247, v24
    v_mul_f32 v25, v247, v25
    v_mul_f32 v26, v247, v26
    v_mul_f32 v27, v247, v27
    v_mul_f32 v28, v247, v28
    v_mul_f32 v29, v247, v29
    v_mul_f32 v30, v247, v30
    v_mul_f32 v31, v247, v31
    v_cvt_pk_bf16_f32 v20, v24, v25
    v_cvt_pk_bf16_f32 v21, v26, v27
    v_cvt_pk_bf16_f32 v22, v28, v29
    v_cvt_pk_bf16_f32 v23, v30, v31
    buffer_store_dwordx4 v[20:23], v244, s[44:47], s5 offen offset:1024 sc1
    v_mul_f32 v32, v247, v32
    v_mul_f32 v33, v247, v33
    v_mul_f32 v34, v247, v34
    v_mul_f32 v35, v247, v35
    v_mul_f32 v36, v247, v36
    v_mul_f32 v37, v247, v37
    v_mul_f32 v38, v247, v38
    v_mul_f32 v39, v247, v39
    v_cvt_pk_bf16_f32 v32, v32, v33
    v_cvt_pk_bf16_f32 v33, v34, v35
    v_cvt_pk_bf16_f32 v34, v36, v37
    v_cvt_pk_bf16_f32 v35, v38, v39
    buffer_store_dwordx4 v[32:35], v244, s[44:47], s6 offen offset:0 sc1
    v_mul_f32 v40, v247, v40
    v_mul_f32 v41, v247, v41
    v_mul_f32 v42, v247, v42
    v_mul_f32 v43, v247, v43
    v_mul_f32 v44, v247, v44
    v_mul_f32 v45, v247, v45
    v_mul_f32 v46, v247, v46
    v_mul_f32 v47, v247, v47
    v_cvt_pk_bf16_f32 v36, v40, v41
    v_cvt_pk_bf16_f32 v37, v42, v43
    v_cvt_pk_bf16_f32 v38, v44, v45
    v_cvt_pk_bf16_f32 v39, v46, v47
    buffer_store_dwordx4 v[36:39], v244, s[44:47], s6 offen offset:1024 sc1
    s_branch L_epiEa
L_epiVa:
    v_mul_f32 v0, v247, v0
    v_mul_f32 v1, v247, v1
    v_mul_f32 v2, v247, v2
    v_mul_f32 v3, v247, v3
    v_mul_f32 v4, v247, v4
    v_mul_f32 v5, v247, v5
    v_mul_f32 v6, v247, v6
    v_mul_f32 v7, v247, v7
    v_cvt_pk_bf16_f32 v0, v0, v1
    v_cvt_pk_bf16_f32 v1, v2, v3
    v_cvt_pk_bf16_f32 v2, v4, v5
    v_cvt_pk_bf16_f32 v3, v6, v7
    ds_write_b128 v88, v[0:3] offset:32768
    v_mul_f32 v8, v247, v8
    v_mul_f32 v9, v247, v9
    v_mul_f32 v10, v247, v10
    v_mul_f32 v11, v247, v11
    v_mul_f32 v12, v247, v12
    v_mul_f32 v13, v247, v13
    v_mul_f32 v14, v247, v14
    v_mul_f32 v15, v247, v15
    v_cvt_pk_bf16_f32 v4, v8, v9
    v_cvt_pk_bf16_f32 v5, v10, v11
    v_cvt_pk_bf16_f32 v6, v12, v13
    v_cvt_pk_bf16_f32 v7, v14, v15
    ds_write_b128 v89, v[4:7] offset:32768
    ds_read_b64_tr_b16 v[8:9], v90 offset:32768
    ds_read_b64_tr_b16 v[10:11], v90 offset:33280
    ds_read_b64_tr_b16 v[12:13], v90 offset:33792
    ds_read_b64_tr_b16 v[14:15], v90 offset:34304
    v_max_f32 v16, 0, v16
    v_mul_f32 v24, v240, v24
    v_mul_f32 v16, v16, v24
    v_max_f32 v17, 0, v17
    v_mul_f32 v25, v240, v25
    v_mul_f32 v17, v17, v25
    v_max_f32 v18, 0, v18
    v_mul_f32 v26, v240, v26
    v_mul_f32 v18, v18, v26
    v_max_f32 v19, 0, v19
    v_mul_f32 v27, v240, v27
    v_mul_f32 v19, v19, v27
    v_max_f32 v20, 0, v20
    v_mul_f32 v28, v240, v28
    v_mul_f32 v20, v20, v28
    v_max_f32 v21, 0, v21
    v_mul_f32 v29, v240, v29
    v_mul_f32 v21, v21, v29
    v_max_f32 v22, 0, v22
    v_mul_f32 v30, v240, v30
    s_waitcnt lgkmcnt(0)
    buffer_store_dwordx4 v[8:11], v91, s[44:47], s4 offen offset:0 sc1
    buffer_store_dwordx4 v[12:15], v91, s[44:47], s4 offen offset:1024 sc1
    v_mul_f32 v22, v22, v30
    v_max_f32 v23, 0, v23
    v_mul_f32 v31, v240, v31
    v_mul_f32 v23, v23, v31
    v_cvt_pk_bf16_f32 v16, v16, v17
    v_cvt_pk_bf16_f32 v17, v18, v19
    v_cvt_pk_bf16_f32 v18, v20, v21
    v_cvt_pk_bf16_f32 v19, v22, v23
    v_max_f32 v32, 0, v32
    v_mul_f32 v40, v240, v40
    v_mul_f32 v32, v32, v40
    v_max_f32 v33, 0, v33
    v_mul_f32 v41, v240, v41
    v_mul_f32 v33, v33, v41
    v_max_f32 v34, 0, v34
    v_mul_f32 v42, v240, v42
    v_mul_f32 v34, v34, v42
    v_max_f32 v35, 0, v35
    v_mul_f32 v43, v240, v43
    v_mul_f32 v35, v35, v43
    v_max_f32 v36, 0, v36
    v_mul_f32 v44, v240, v44
    v_mul_f32 v36, v36, v44
    v_max_f32 v37, 0, v37
    v_mul_f32 v45, v240, v45
    v_mul_f32 v37, v37, v45
    v_max_f32 v38, 0, v38
    v_mul_f32 v46, v240, v46
    v_mul_f32 v38, v38, v46
    v_max_f32 v39, 0, v39
    v_mul_f32 v47, v240, v47
    v_mul_f32 v39, v39, v47
    v_cvt_pk_bf16_f32 v32, v32, v33
    v_cvt_pk_bf16_f32 v33, v34, v35
    v_cvt_pk_bf16_f32 v34, v36, v37
    v_cvt_pk_bf16_f32 v35, v38, v39
    s_branch L_epiEa
L_epiGa:
    v_max_f32 v16, 0, v16
    v_mul_f32 v24, v240, v24
    v_mul_f32 v16, v16, v24
    v_max_f32 v17, 0, v17
    v_mul_f32 v25, v240, v25
    v_mul_f32 v17, v17, v25
    v_max_f32 v18, 0, v18
    v_mul_f32 v26, v240, v26
    v_mul_f32 v18, v18, v26
    v_max_f32 v19, 0, v19
    v_mul_f32 v27, v240, v27
    v_mul_f32 v19, v19, v27
    v_max_f32 v20, 0, v20
    v_mul_f32 v28, v240, v28
    v_mul_f32 v20, v20, v28
    v_max_f32 v21, 0, v21
    v_mul_f32 v29, v240, v29
    v_mul_f32 v21, v21, v29
    v_max_f32 v22, 0, v22
    v_mul_f32 v30, v240, v30
    v_mul_f32 v22, v22, v30
    v_max_f32 v23, 0, v23
    v_mul_f32 v31, v240, v31
    v_mul_f32 v23, v23, v31
    v_cvt_pk_bf16_f32 v16, v16, v17
    v_cvt_pk_bf16_f32 v17, v18, v19
    v_cvt_pk_bf16_f32 v18, v20, v21
    v_cvt_pk_bf16_f32 v19, v22, v23
    v_max_f32 v32, 0, v32
    v_mul_f32 v40, v240, v40
    v_mul_f32 v32, v32, v40
    v_max_f32 v33, 0, v33
    v_mul_f32 v41, v240, v41
    v_mul_f32 v33, v33, v41
    v_max_f32 v34, 0, v34
    v_mul_f32 v42, v240, v42
    v_mul_f32 v34, v34, v42
    v_max_f32 v35, 0, v35
    v_mul_f32 v43, v240, v43
    v_mul_f32 v35, v35, v43
    v_max_f32 v36, 0, v36
    v_mul_f32 v44, v240, v44
    v_mul_f32 v36, v36, v44
    v_max_f32 v37, 0, v37
    v_mul_f32 v45, v240, v45
    v_mul_f32 v37, v37, v45
    v_max_f32 v38, 0, v38
    v_mul_f32 v46, v240, v46
    v_mul_f32 v38, v38, v46
    v_max_f32 v39, 0, v39
    v_mul_f32 v47, v240, v47
    v_mul_f32 v39, v39, v47
    v_cvt_pk_bf16_f32 v32, v32, v33
    v_cvt_pk_bf16_f32 v33, v34, v35
    v_cvt_pk_bf16_f32 v34, v36, v37
    v_cvt_pk_bf16_f32 v35, v38, v39
L_epiEa:
    s_setprio 1
    s_add_u32 m0, s73, 106496
    s_waitcnt lgkmcnt(2)
    v_mfma_f32_32x32x16_bf16 v[48:63], v[80:83], v[128:131], 0
    ds_read_b64_tr_b16 v[92:93], v105 offset:49152
    ds_read_b64_tr_b16 v[94:95], v105 offset:49664
    buffer_load_dwordx4 v242, s[36:39], s71 offen lds
    v_mfma_f32_16x16x32_bf16 v[116:119], v[112:115], v[80:83], 0
    s_add_u32 m0, s73, 114688
    s_waitcnt lgkmcnt(2)
    v_mfma_f32_32x32x16_bf16 v[64:79], v[84:87], v[128:131], 0
    ds_read_b64_tr_b16 v[96:97], v109 offset:49152
    ds_read_b64_tr_b16 v[98:99], v109 offset:49664
    buffer_load_dwordx4 v243, s[40:43], s71 offen lds
    s_waitcnt lgkmcnt(2)
    v_mfma_f32_32x32x16_bf16 v[48:63], v[92:95], v[132:135], v[48:63]
    ds_read_b64_tr_b16 v[80:81], v106 offset:49152
    ds_read_b64_tr_b16 v[82:83], v106 offset:49664
    s_waitcnt lgkmcnt(2)
    v_mfma_f32_32x32x16_bf16 v[64:79], v[96:99], v[132:135], v[64:79]
    ds_read_b64_tr_b16 v[84:85], v110 offset:49152
    ds_read_b64_tr_b16 v[86:87], v110 offset:49664
    v_mfma_f32_16x16x32_bf16 v[120:123], v[112:115], v[96:99], 0
    s_waitcnt lgkmcnt(2)
    v_mfma_f32_32x32x16_bf16 v[48:63], v[80:83], v[136:139], v[48:63]
    ds_read_b64_tr_b16 v[92:93], v107 offset:49152
    ds_read_b64_tr_b16 v[94:95], v107 offset:49664
    ds_read_b64_tr_b16 v[96:97], v111 offset:49152
    ds_read_b64_tr_b16 v[98:99], v111 offset:49664
    s_waitcnt lgkmcnt(4)
    v_mfma_f32_32x32x16_bf16 v[64:79], v[84:87], v[136:139], v[64:79]
    ds_read_b64_tr_b16 v[128:129], v104 offset:0
    ds_read_b64_tr_b16 v[130:131], v104 offset:512
    ds_read_b64_tr_b16 v[132:133], v108 offset:0
    ds_read_b64_tr_b16 v[134:135], v108 offset:512
    v_add_u32 v104, 65536, v104
    v_add_u32 v108, 65536, v108
    s_waitcnt lgkmcnt(6)
    v_mfma_f32_32x32x16_bf16 v[48:63], v[92:95], v[140:143], v[48:63]
    ds_read_b64_tr_b16 v[80:81], v105 offset:0
    ds_read_b64_tr_b16 v[82:83], v105 offset:512
    s_waitcnt lgkmcnt(6)
    v_mfma_f32_32x32x16_bf16 v[64:79], v[96:99], v[140:143], v[64:79]
    ds_read_b64_tr_b16 v[84:85], v109 offset:0
    ds_read_b64_tr_b16 v[86:87], v109 offset:512
    v_add_u32 v105, 65536, v105
    v_add_u32 v109, 65536, v109
    s_waitcnt lgkmcnt(6)
    v_mfma_f32_32x32x16_bf16 v[48:63], v[128:131], v[144:147], v[48:63]
    ds_read_b64_tr_b16 v[92:93], v106 offset:0
    ds_read_b64_tr_b16 v[94:95], v106 offset:512
    v_mfma_f32_16x16x32_bf16 v[116:119], v[112:115], v[128:131], v[116:119]
    s_waitcnt lgkmcnt(6)
    v_mfma_f32_32x32x16_bf16 v[64:79], v[132:135], v[144:147], v[64:79]
    ds_read_b64_tr_b16 v[96:97], v110 offset:0
    ds_read_b64_tr_b16 v[98:99], v110 offset:512
    v_add_u32 v106, 65536, v106
    v_add_u32 v110, 65536, v110
    s_waitcnt lgkmcnt(6)
    v_mfma_f32_32x32x16_bf16 v[48:63], v[80:83], v[148:151], v[48:63]
    ds_read_b64_tr_b16 v[128:129], v107 offset:0
    ds_read_b64_tr_b16 v[130:131], v107 offset:512
    s_lshr_b32 s82, s65, 4
    s_lshl1_add_u32 s66, s64, s82
    s_and_b32 s67, s65, 15
    s_waitcnt lgkmcnt(6)
    v_mfma_f32_32x32x16_bf16 v[64:79], v[84:87], v[148:151], v[64:79]
    ds_read_b64_tr_b16 v[132:133], v111 offset:0
    ds_read_b64_tr_b16 v[134:135], v111 offset:512
    s_cmp_eq_u32 s82, 0
    s_cselect_b32 s53, -1, 0
    s_cselect_b32 s54, 0, -1
    s_mov_b32 s52, 0
    s_mov_b32 s55, 0
    v_add_u32 v107, 65536, v107
    v_add_u32 v111, 65536, v111
    v_mfma_f32_16x16x32_bf16 v[120:123], v[112:115], v[84:87], v[120:123]
    s_waitcnt lgkmcnt(6)
    v_mfma_f32_32x32x16_bf16 v[48:63], v[92:95], v[152:155], v[48:63]
    ds_read_b64_tr_b16 v[80:81], v104 offset:24576
    ds_read_b64_tr_b16 v[82:83], v104 offset:25088
    s_mul_i32 s83, s66, 7
    v_and_b32 v124, 1, v245
    v_mul_u32_u24 v125, 6, v124
    s_waitcnt lgkmcnt(6)
    v_mfma_f32_32x32x16_bf16 v[64:79], v[96:99], v[152:155], v[64:79]
    ds_read_b64_tr_b16 v[84:85], v108 offset:24576
    ds_read_b64_tr_b16 v[86:87], v108 offset:25088
    v_add_u32 v125, s83, v125
    v_lshrrev_b32 v125, 4, v125
    s_mov_b32 s84, 0x5333222
    s_waitcnt lgkmcnt(6)
    v_mfma_f32_32x32x16_bf16 v[48:63], v[128:131], v[156:159], v[48:63]
    ds_read_b64_tr_b16 v[92:93], v105 offset:24576
    ds_read_b64_tr_b16 v[94:95], v105 offset:25088
    v_mov_b32 v126, s84
    s_mov_b32 exec_lo, 0xffff0000
    s_mov_b32 exec_hi, 0x0
    v_mov_b32 v126, 0xedcba98
    s_mov_b64 exec, -1
    s_mov_b32 exec_lo, 0x0
    s_mov_b32 exec_hi, 0xffff
    v_mov_b32 v126, 0x4111000
    s_mov_b64 exec, -1
    s_waitcnt lgkmcnt(6)
    v_mfma_f32_32x32x16_bf16 v[64:79], v[132:135], v[156:159], v[64:79]
    ds_read_b64_tr_b16 v[96:97], v109 offset:24576
    ds_read_b64_tr_b16 v[98:99], v109 offset:25088
    v_lshlrev_b32 v125, 2, v125
    v_bfe_u32 v126, v126, v125, 4
    v_bfe_u32 v125, v245, 2, 2
    s_waitcnt lgkmcnt(6)
    v_mfma_f32_32x32x16_bf16 v[48:63], v[80:83], v[160:163], v[48:63]
    ds_read_b64_tr_b16 v[128:129], v106 offset:24576
    ds_read_b64_tr_b16 v[130:131], v106 offset:25088
    s_lshl_b32 s84, s60, 2
    v_add_u32 v125, s84, v125
    s_mov_b32 exec_lo, 0
    s_mov_b32 exec_hi, 0xffff0000
    v_mov_b32 v126, s66
    s_mov_b32 exec_hi, 0xaaaaffff
    v_mov_b32 v125, s67
    s_mov_b64 exec, -1
    v_mfma_f32_16x16x32_bf16 v[116:119], v[112:115], v[80:83], v[116:119]
    s_waitcnt lgkmcnt(6)
    v_mfma_f32_32x32x16_bf16 v[64:79], v[84:87], v[160:163], v[64:79]
    ds_read_b64_tr_b16 v[132:133], v110 offset:24576
    ds_read_b64_tr_b16 v[134:135], v110 offset:25088
    v_lshl_add_u32 v126, v125, 4, v126
    v_lshlrev_b32 v126, 7, v126
    v_add_u32 v126, 4096, v126
    s_waitcnt lgkmcnt(6)
    v_mfma_f32_32x32x16_bf16 v[48:63], v[92:95], v[164:167], v[48:63]
    ds_read_b64_tr_b16 v[80:81], v107 offset:24576
    ds_read_b64_tr_b16 v[82:83], v107 offset:25088
    s_lshr_b32 s83, s83, 1
    s_lshl_b32 s83, s83, 9
    s_add_u32 s71, s83, 1077248
    s_waitcnt lgkmcnt(6)
    v_mfma_f32_32x32x16_bf16 v[64:79], v[96:99], v[164:167], v[64:79]
    ds_read_b64_tr_b16 v[84:85], v111 offset:24576
    ds_read_b64_tr_b16 v[86:87], v111 offset:25088
    s_mul_i32 s84, s60, 917504
    s_add_u32 s20, s71, s84
    s_add_u32 s21, s20, 57344
    v_mfma_f32_16x16x32_bf16 v[120:123], v[112:115], v[96:99], v[120:123]
    s_waitcnt lgkmcnt(6)
    v_mfma_f32_32x32x16_bf16 v[48:63], v[128:131], v[168:171], v[48:63]
    ds_read_b64_tr_b16 v[92:93], v104 offset:57344
    ds_read_b64_tr_b16 v[94:95], v104 offset:57856
    s_add_u32 s22, s20, 114688
    s_add_u32 s23, s20, 172032
    s_add_u32 s24, s20, 229376
    s_waitcnt lgkmcnt(6)
    v_mfma_f32_32x32x16_bf16 v[64:79], v[132:135], v[168:171], v[64:79]
    ds_read_b64_tr_b16 v[96:97], v108 offset:57344
    ds_read_b64_tr_b16 v[98:99], v108 offset:57856
    s_add_u32 s25, s20, 286720
    s_add_u32 s26, s20, 344064
    s_add_u32 s27, s20, 401408
    v_subrev_u32 v104, 65536, v104
    v_subrev_u32 v108, 65536, v108
    s_waitcnt lgkmcnt(6)
    v_mfma_f32_32x32x16_bf16 v[48:63], v[80:83], v[172:175], v[48:63]
    ds_read_b64_tr_b16 v[128:129], v105 offset:57344
    ds_read_b64_tr_b16 v[130:131], v105 offset:57856
    s_add_u32 s28, s20, 458752
    s_add_u32 s29, s20, 516096
    s_add_u32 s30, s20, 573440
    s_waitcnt lgkmcnt(6)
    v_mfma_f32_32x32x16_bf16 v[64:79], v[84:87], v[172:175], v[64:79]
    ds_read_b64_tr_b16 v[132:133], v109 offset:57344
    ds_read_b64_tr_b16 v[134:135], v109 offset:57856
    s_add_u32 s31, s20, 630784
    s_add_u32 s32, s20, 688128
    s_add_u32 s33, s20, 745472
    v_subrev_u32 v105, 65536, v105
    v_subrev_u32 v109, 65536, v109
    s_waitcnt lgkmcnt(6)
    v_mfma_f32_32x32x16_bf16 v[48:63], v[92:95], v[176:179], v[48:63]
    ds_read_b64_tr_b16 v[80:81], v106 offset:57344
    ds_read_b64_tr_b16 v[82:83], v106 offset:57856
    s_add_u32 s34, s20, 802816
    s_add_u32 s35, s20, 860160
    s_lshl2_add_u32 s84, s66, s60
    v_mfma_f32_16x16x32_bf16 v[116:119], v[112:115], v[92:95], v[116:119]
    s_waitcnt lgkmcnt(6)
    v_mfma_f32_32x32x16_bf16 v[64:79], v[96:99], v[176:179], v[64:79]
    ds_read_b64_tr_b16 v[84:85], v110 offset:57344
    ds_read_b64_tr_b16 v[86:87], v110 offset:57856
    s_lshl_b32 s84, s84, 15
    s_add_u32 s36, s84, 4718592
    s_add_u32 s37, s84, 4722688
    v_subrev_u32 v106, 65536, v106
    v_subrev_u32 v110, 65536, v110
    s_waitcnt lgkmcnt(6)
    v_mfma_f32_32x32x16_bf16 v[48:63], v[128:131], v[180:183], v[48:63]
    ds_read_b64_tr_b16 v[92:93], v107 offset:57344
    ds_read_b64_tr_b16 v[94:95], v107 offset:57856
    s_waitcnt vmcnt(2)
    s_barrier
    s_add_u32 s38, s84, 4726784
    s_add_u32 s39, s84, 4730880
    s_add_u32 s40, s84, 4734976
    s_waitcnt lgkmcnt(6)
    v_mfma_f32_32x32x16_bf16 v[64:79], v[132:135], v[180:183], v[64:79]
    ds_read_b64_tr_b16 v[96:97], v111 offset:57344
    ds_read_b64_tr_b16 v[98:99], v111 offset:57856
    s_add_u32 s41, s84, 4739072
    s_add_u32 s42, s84, 4743168
    s_add_u32 s43, s84, 4747264
    v_subrev_u32 v107, 65536, v107
    v_subrev_u32 v111, 65536, v111
    v_mfma_f32_16x16x32_bf16 v[120:123], v[112:115], v[132:135], v[120:123]
    s_waitcnt lgkmcnt(6)
    v_mfma_f32_32x32x16_bf16 v[48:63], v[80:83], v[184:187], v[48:63]
    ds_read_b64_tr_b16 v[128:129], v104 offset:16384
    ds_read_b64_tr_b16 v[130:131], v104 offset:16896
    s_cmp_eq_u32 s78, 0
    s_cbranch_scc1 L_gusa
    buffer_store_dwordx4 v[16:19], v244, s[44:47], s7 offen offset:0 sc1
    buffer_store_dwordx4 v[32:35], v244, s[44:47], s7 offen offset:1024 sc1
L_gusa:
    s_mul_i32 s82, s67, 229376
    s_add_u32 s82, s82, s83
    s_add_u32 s82, s82, 1048576
    s_waitcnt lgkmcnt(6)
    v_mfma_f32_32x32x16_bf16 v[64:79], v[84:87], v[184:187], v[64:79]
    ds_read_b64_tr_b16 v[132:133], v108 offset:16384
    ds_read_b64_tr_b16 v[134:135], v108 offset:16896
    s_add_u32 s83, s60, 1
    s_and_b32 s83, s83, 3
    s_lshl_b32 s12, s83, 12
    v_add_u32 v104, 65536, v104
    v_add_u32 v108, 65536, v108
    s_waitcnt lgkmcnt(6)
    v_mfma_f32_32x32x16_bf16 v[48:63], v[92:95], v[188:191], v[48:63]
    ds_read_b64_tr_b16 v[80:81], v105 offset:16384
    ds_read_b64_tr_b16 v[82:83], v105 offset:16896
    s_mul_i32 s83, s83, 57344
    s_add_u32 s48, s83, s82
    s_add_u32 s12, s12, 114688
    s_waitcnt lgkmcnt(6)
    v_mfma_f32_32x32x16_bf16 v[64:79], v[96:99], v[188:191], v[64:79]
    ds_read_b64_tr_b16 v[84:85], v109 offset:16384
    ds_read_b64_tr_b16 v[86:87], v109 offset:16896
    s_add_u32 s83, s60, 2
    s_and_b32 s83, s83, 3
    s_lshl_b32 s13, s83, 12
    v_add_u32 v105, 65536, v105
    v_add_u32 v109, 65536, v109
    s_waitcnt lgkmcnt(6)
    v_mfma_f32_32x32x16_bf16 v[48:63], v[128:131], v[192:195], v[48:63]
    ds_read_b64_tr_b16 v[92:93], v106 offset:16384
    ds_read_b64_tr_b16 v[94:95], v106 offset:16896
    s_mul_i32 s83, s83, 57344
    s_add_u32 s49, s83, s82
    s_add_u32 s13, s13, 131072
    v_mfma_f32_16x16x32_bf16 v[116:119], v[112:115], v[128:131], v[116:119]
    s_waitcnt lgkmcnt(6)
    v_mfma_f32_32x32x16_bf16 v[64:79], v[132:135], v[192:195], v[64:79]
    ds_read_b64_tr_b16 v[96:97], v110 offset:16384
    ds_read_b64_tr_b16 v[98:99], v110 offset:16896
    s_add_u32 s83, s60, 3
    s_and_b32 s83, s83, 3
    s_lshl_b32 s14, s83, 12
    v_add_u32 v106, 65536, v106
    v_add_u32 v110, 65536, v110
    s_waitcnt lgkmcnt(6)
    v_mfma_f32_32x32x16_bf16 v[48:63], v[80:83], v[196:199], v[48:63]
    ds_read_b64_tr_b16 v[128:129], v107 offset:16384
    ds_read_b64_tr_b16 v[130:131], v107 offset:16896
    s_mul_i32 s83, s83, 57344
    s_add_u32 s50, s83, s82
    s_add_u32 s14, s14, 147456
    s_waitcnt lgkmcnt(6)
    v_mfma_f32_32x32x16_bf16 v[64:79], v[84:87], v[196:199], v[64:79]
    ds_read_b64_tr_b16 v[132:133], v111 offset:16384
    ds_read_b64_tr_b16 v[134:135], v111 offset:16896
    s_add_u32 s83, s60, 4
    s_and_b32 s83, s83, 3
    s_lshl_b32 s15, s83, 12
    v_add_u32 v107, 65536, v107
    v_add_u32 v111, 65536, v111
    v_mfma_f32_16x16x32_bf16 v[120:123], v[112:115], v[84:87], v[120:123]
    s_waitcnt lgkmcnt(6)
    v_mfma_f32_32x32x16_bf16 v[48:63], v[92:95], v[200:203], v[48:63]
    s_waitcnt vmcnt(0)
    s_barrier
    ds_read_b64_tr_b16 v[80:81], v104 offset:0
    ds_read_b64_tr_b16 v[82:83], v104 offset:512
    s_mul_i32 s83, s83, 57344
    s_add_u32 s51, s83, s82
    s_add_u32 s15, s15, 114688
    s_waitcnt lgkmcnt(6)
    v_mfma_f32_32x32x16_bf16 v[64:79], v[96:99], v[200:203], v[64:79]
    ds_read_b64_tr_b16 v[84:85], v108 offset:0
    ds_read_b64_tr_b16 v[86:87], v108 offset:512
    s_lshl2_add_u32 s82, s67, s60
    s_lshl4_add_u32 s82, s82, s66
    s_lshl_b32 s82, s82, 11
    s_add_u32 s70, s82, 6815744
    s_waitcnt lgkmcnt(6)
    v_mfma_f32_32x32x16_bf16 v[48:63], v[128:131], v[204:207], v[48:63]
    ds_read_b64_tr_b16 v[92:93], v105 offset:0
    ds_read_b64_tr_b16 v[94:95], v105 offset:512
    s_waitcnt lgkmcnt(6)
    v_mfma_f32_32x32x16_bf16 v[64:79], v[132:135], v[204:207], v[64:79]
    ds_read_b64_tr_b16 v[96:97], v109 offset:0
    ds_read_b64_tr_b16 v[98:99], v109 offset:512
    buffer_load_dword v127, v126, s[44:47], 0 offen sc1
    s_waitcnt lgkmcnt(6)
    v_mfma_f32_32x32x16_bf16 v[48:63], v[80:83], v[208:211], v[48:63]
    ds_read_b64_tr_b16 v[128:129], v106 offset:0
    ds_read_b64_tr_b16 v[130:131], v106 offset:512
    v_mfma_f32_16x16x32_bf16 v[116:119], v[112:115], v[80:83], v[116:119]
    s_waitcnt lgkmcnt(6)
    v_mfma_f32_32x32x16_bf16 v[64:79], v[84:87], v[208:211], v[64:79]
    ds_read_b64_tr_b16 v[132:133], v110 offset:0
    ds_read_b64_tr_b16 v[134:135], v110 offset:512
    s_waitcnt lgkmcnt(6)
    v_mfma_f32_32x32x16_bf16 v[48:63], v[92:95], v[212:215], v[48:63]
    ds_read_b64_tr_b16 v[80:81], v107 offset:0
    ds_read_b64_tr_b16 v[82:83], v107 offset:512
    s_waitcnt lgkmcnt(6)
    v_mfma_f32_32x32x16_bf16 v[64:79], v[96:99], v[212:215], v[64:79]
    ds_read_b64_tr_b16 v[84:85], v111 offset:0
    ds_read_b64_tr_b16 v[86:87], v111 offset:512
    v_mfma_f32_16x16x32_bf16 v[120:123], v[112:115], v[96:99], v[120:123]
    s_waitcnt lgkmcnt(6)
    v_mfma_f32_32x32x16_bf16 v[48:63], v[128:131], v[216:219], v[48:63]
    ds_read_b64_tr_b16 v[92:93], v104 offset:40960
    ds_read_b64_tr_b16 v[94:95], v104 offset:41472
    s_waitcnt lgkmcnt(6)
    v_mfma_f32_32x32x16_bf16 v[64:79], v[132:135], v[216:219], v[64:79]
    ds_read_b64_tr_b16 v[96:97], v108 offset:40960
    ds_read_b64_tr_b16 v[98:99], v108 offset:41472
    s_waitcnt lgkmcnt(6)
    v_mfma_f32_32x32x16_bf16 v[48:63], v[80:83], v[220:223], v[48:63]
    ds_read_b64_tr_b16 v[128:129], v105 offset:40960
    ds_read_b64_tr_b16 v[130:131], v105 offset:41472
    s_waitcnt lgkmcnt(6)
    v_mfma_f32_32x32x16_bf16 v[64:79], v[84:87], v[220:223], v[64:79]
    ds_read_b64_tr_b16 v[132:133], v109 offset:40960
    ds_read_b64_tr_b16 v[134:135], v109 offset:41472
    s_lshl_b32 s82, s79, 2
    v_add_u32 v88, s82, v241
    s_waitcnt lgkmcnt(6)
    v_mfma_f32_32x32x16_bf16 v[48:63], v[92:95], v[224:227], v[48:63]
    ds_read_b64_tr_b16 v[80:81], v106 offset:40960
    ds_read_b64_tr_b16 v[82:83], v106 offset:41472
    s_waitcnt vmcnt(0)
    v_cmp_ne_u32 vcc, s63, v127
    s_nop 2
    s_cbranch_vccz L_pqok
    s_mov_b32 s87, 0
L_pq:
    buffer_load_dword v127, v126, s[44:47], 0 offen sc1
    s_add_u32 s87, s87, 1
    s_waitcnt vmcnt(0)
    v_cmp_ne_u32 vcc, s63, v127
    s_cmp_lt_u32 s87, 100000
    s_cselect_b64 s[84:85], -1, 0
    s_nop 0
    s_and_b64 vcc, vcc, s[84:85]
    s_cbranch_vccnz L_pq
L_pqok:
    v_mfma_f32_16x16x32_bf16 v[116:119], v[112:115], v[92:95], v[116:119]
    s_waitcnt lgkmcnt(6)
    v_mfma_f32_32x32x16_bf16 v[64:79], v[96:99], v[224:227], v[64:79]
    ds_read_b64_tr_b16 v[84:85], v110 offset:40960
    ds_read_b64_tr_b16 v[86:87], v110 offset:41472
    buffer_load_dwordx4 v[136:139], v244, s[44:47], s48 offen offset:0 sc1
    buffer_load_dwordx4 v[140:143], v244, s[44:47], s48 offen offset:1024 sc1
    v_mfma_f32_16x16x32_bf16 v[120:123], v[112:115], v[96:99], v[120:123]
    s_waitcnt lgkmcnt(6)
    v_mfma_f32_32x32x16_bf16 v[48:63], v[128:131], v[228:231], v[48:63]
    ds_read_b64_tr_b16 v[92:93], v107 offset:40960
    ds_read_b64_tr_b16 v[94:95], v107 offset:41472
    buffer_load_dwordx4 v[168:171], v244, s[44:47], s20 offen offset:0 sc1
    buffer_load_dwordx4 v[172:175], v244, s[44:47], s20 offen offset:1024 sc1
    s_waitcnt lgkmcnt(6)
    v_mfma_f32_32x32x16_bf16 v[64:79], v[132:135], v[228:231], v[64:79]
    ds_write_b32 v88, v116 offset:0
    ds_write_b32 v88, v120 offset:1024
    ds_read_b64_tr_b16 v[96:97], v111 offset:40960
    ds_read_b64_tr_b16 v[98:99], v111 offset:41472
    s_waitcnt vmcnt(5)
    buffer_load_dwordx4 v[144:147], v244, s[44:47], s49 offen offset:0 sc1
    buffer_load_dwordx4 v[148:151], v244, s[44:47], s49 offen offset:1024 sc1
    s_waitcnt lgkmcnt(8)
    v_mfma_f32_32x32x16_bf16 v[48:63], v[80:83], v[232:235], v[48:63]
    s_waitcnt lgkmcnt(2)
    s_barrier
    ds_read_b128 v[116:119], v241 offset:0
    ds_read_b128 v[120:123], v241 offset:1024
    buffer_load_dwordx4 v[176:179], v244, s[44:47], s36 offen offset:0 sc1
    buffer_load_dwordx4 v[180:183], v244, s[44:47], s36 offen offset:1024 sc1
    v_mfma_f32_32x32x16_bf16 v[64:79], v[84:87], v[232:235], v[64:79]
    buffer_load_dwordx4 v[152:155], v244, s[44:47], s50 offen offset:0 sc1
    buffer_load_dwordx4 v[156:159], v244, s[44:47], s50 offen offset:1024 sc1
    s_waitcnt lgkmcnt(1)
    v_add_f32 v116, v116, v117
    v_add_f32 v118, v118, v119
    v_add_f32 v116, v116, v118
    v_and_b32 v117, s74, v116
    v_lshrrev_b32 v253, 16, v116
    v_sub_f32 v118, v116, v117
    v_cvt_pk_bf16_f32 v252, v117, v118
    s_nop 1
    v_mfma_f32_32x32x16_bf16 v[48:63], v[252:255], v[248:251], v[48:63]
    v_mfma_f32_32x32x16_bf16 v[48:63], v[92:95], v[236:239], v[48:63]
    buffer_load_dwordx4 v[160:163], v244, s[44:47], s51 offen offset:0 sc1
    buffer_load_dwordx4 v[164:167], v244, s[44:47], s51 offen offset:1024 sc1
    s_waitcnt lgkmcnt(0)
    v_add_f32 v120, v120, v121
    v_add_f32 v122, v122, v123
    v_add_f32 v120, v120, v122
    v_and_b32 v121, s74, v120
    v_lshrrev_b32 v253, 16, v120
    v_sub_f32 v122, v120, v121
    v_cvt_pk_bf16_f32 v252, v121, v122
    s_nop 1
    v_mfma_f32_32x32x16_bf16 v[64:79], v[252:255], v[248:251], v[64:79]
    v_mfma_f32_32x32x16_bf16 v[64:79], v[96:99], v[236:239], v[64:79]
    buffer_load_dwordx4 v[184:187], v244, s[44:47], s21 offen offset:0 sc1
    buffer_load_dwordx4 v[188:191], v244, s[44:47], s21 offen offset:1024 sc1
    s_barrier
    v_max_f32 v48, 0, v48
    v_mul_f32 v56, v240, v56
    v_mul_f32 v48, v48, v56
    v_max_f32 v49, 0, v49
    v_mul_f32 v57, v240, v57
    v_mul_f32 v49, v49, v57
    v_max_f32 v50, 0, v50
    v_mul_f32 v58, v240, v58
    v_mul_f32 v50, v50, v58
    v_max_f32 v51, 0, v51
    v_mul_f32 v59, v240, v59
    v_mul_f32 v51, v51, v59
    v_max_f32 v52, 0, v52
    v_mul_f32 v60, v240, v60
    v_mul_f32 v52, v52, v60
    v_max_f32 v53, 0, v53
    v_mul_f32 v61, v240, v61
    v_mul_f32 v53, v53, v61
    v_max_f32 v54, 0, v54
    v_mul_f32 v62, v240, v62
    v_mul_f32 v54, v54, v62
    v_max_f32 v55, 0, v55
    v_mul_f32 v63, v240, v63
    v_mul_f32 v55, v55, v63
    v_cvt_pk_bf16_f32 v128, v48, v49
    v_cvt_pk_bf16_f32 v129, v50, v51
    v_cvt_pk_bf16_f32 v130, v52, v53
    buffer_load_dwordx4 v[192:195], v244, s[44:47], s36 offen offset:2048 sc1
    v_cvt_pk_bf16_f32 v131, v54, v55
    v_max_f32 v64, 0, v64
    v_mul_f32 v72, v240, v72
    v_mul_f32 v64, v64, v72
    v_max_f32 v65, 0, v65
    v_mul_f32 v73, v240, v73
    v_mul_f32 v65, v65, v73
    v_max_f32 v66, 0, v66
    v_mul_f32 v74, v240, v74
    v_mul_f32 v66, v66, v74
    v_max_f32 v67, 0, v67
    v_mul_f32 v75, v240, v75
    v_mul_f32 v67, v67, v75
    v_max_f32 v68, 0, v68
    v_mul_f32 v76, v240, v76
    v_mul_f32 v68, v68, v76
    v_max_f32 v69, 0, v69
    v_mul_f32 v77, v240, v77
    v_mul_f32 v69, v69, v77
    v_max_f32 v70, 0, v70
    v_mul_f32 v78, v240, v78
    v_mul_f32 v70, v70, v78
    v_max_f32 v71, 0, v71
    v_mul_f32 v79, v240, v79
    v_mul_f32 v71, v71, v79
    v_cvt_pk_bf16_f32 v132, v64, v65
    v_cvt_pk_bf16_f32 v133, v66, v67
    v_cvt_pk_bf16_f32 v134, v68, v69
    buffer_load_dwordx4 v[196:199], v244, s[44:47], s36 offen offset:3072 sc1
    v_cvt_pk_bf16_f32 v135, v70, v71
    s_setprio 2
    s_waitcnt vmcnt(15)
    v_cndmask_b32 v136, v136, 0, s[54:55]
    v_cndmask_b32 v137, v137, 0, s[54:55]
    s_waitcnt vmcnt(14)
    v_cndmask_b32 v142, v142, 0, s[52:53]
    v_cndmask_b32 v143, v143, 0, s[52:53]
    s_waitcnt vmcnt(13)
    v_mfma_f32_32x32x16_bf16 v[64:79], v[168:171], v[136:139], 0
    s_waitcnt vmcnt(12)
    v_mfma_f32_32x32x16_bf16 v[64:79], v[172:175], v[140:143], v[64:79]
    s_waitcnt vmcnt(11)
    v_cndmask_b32 v144, v144, 0, s[54:55]
    v_cndmask_b32 v145, v145, 0, s[54:55]
    s_waitcnt vmcnt(10)
    v_cndmask_b32 v150, v150, 0, s[52:53]
    v_cndmask_b32 v151, v151, 0, s[52:53]
    v_add_u32 v120, s12, v244
    v_add_u32 v121, s13, v244
    v_add_u32 v122, s14, v244
    v_add_u32 v123, s15, v244
    s_mov_b32 s82, 0x5d800000
    v_mov_b32 v112, -1
    ds_write_b32 v123, v112 offset:3072
    ds_write_b32 v123, v112 offset:19456
    ds_write_b32 v123, v112 offset:35840
    v_mfma_f32_32x32x16_bf16 v[80:95], v[168:171], v[144:147], 0
    buffer_load_dwordx4 v[200:203], v244, s[44:47], s22 offen offset:0 sc1
    v_exp_f32 v112, v64
    v_exp_f32 v113, v65
    v_exp_f32 v114, v66
    v_exp_f32 v115, v67
    v_mfma_f32_32x32x16_bf16 v[80:95], v[172:175], v[148:151], v[80:95]
    buffer_load_dwordx4 v[204:207], v244, s[44:47], s22 offen offset:1024 sc1
    v_cvt_pk_bf16_f32 v96, v112, v113
    v_cvt_pk_bf16_f32 v97, v114, v115
    v_exp_f32 v116, v68
    v_exp_f32 v117, v69
    v_exp_f32 v118, v70
    v_exp_f32 v119, v71
    buffer_load_dwordx4 v[208:211], v244, s[44:47], s37 offen offset:0 sc1
    v_cvt_pk_bf16_f32 v98, v116, v117
    v_cvt_pk_bf16_f32 v99, v118, v119
    v_exp_f32 v112, v72
    v_exp_f32 v113, v73
    v_exp_f32 v114, v74
    v_exp_f32 v115, v75
    s_waitcnt vmcnt(12)
    v_mfma_f32_32x32x16_bf16 v[0:15], v[176:179], v[96:99], 0
    buffer_load_dwordx4 v[212:215], v244, s[44:47], s37 offen offset:1024 sc1
    s_waitcnt vmcnt(11)
    v_cndmask_b32 v152, v152, 0, s[54:55]
    v_cndmask_b32 v153, v153, 0, s[54:55]
    s_waitcnt vmcnt(10)
    v_cndmask_b32 v158, v158, 0, s[52:53]
    v_cndmask_b32 v159, v159, 0, s[52:53]
    v_cvt_pk_bf16_f32 v100, v112, v113
    v_cvt_pk_bf16_f32 v101, v114, v115
    v_exp_f32 v116, v76
    v_exp_f32 v117, v77
    v_exp_f32 v118, v78
    v_exp_f32 v119, v79
    v_mfma_f32_32x32x16_bf16 v[64:79], v[168:171], v[152:155], 0
    v_cvt_pk_bf16_f32 v102, v116, v117
    v_cvt_pk_bf16_f32 v103, v118, v119
    v_exp_f32 v112, v80
    v_exp_f32 v113, v81
    v_exp_f32 v114, v82
    v_exp_f32 v115, v83
    v_mfma_f32_32x32x16_bf16 v[64:79], v[172:175], v[156:159], v[64:79]
    v_cvt_pk_bf16_f32 v104, v112, v113
    v_cvt_pk_bf16_f32 v105, v114, v115
    v_exp_f32 v116, v84
    v_exp_f32 v117, v85
    v_exp_f32 v118, v86
    v_exp_f32 v119, v87
    v_mfma_f32_32x32x16_bf16 v[0:15], v[180:183], v[100:103], v[0:15]
    v_cvt_pk_bf16_f32 v106, v116, v117
    v_cvt_pk_bf16_f32 v107, v118, v119
    v_exp_f32 v112, v88
    v_exp_f32 v113, v89
    v_exp_f32 v114, v90
    v_exp_f32 v115, v91
    v_mfma_f32_32x32x16_bf16 v[16:31], v[176:179], v[104:107], 0
    s_waitcnt vmcnt(9)
    v_cndmask_b32 v160, v160, 0, s[54:55]
    v_cndmask_b32 v161, v161, 0, s[54:55]
    s_waitcnt vmcnt(8)
    v_cndmask_b32 v166, v166, 0, s[52:53]
    v_cndmask_b32 v167, v167, 0, s[52:53]
    v_cvt_pk_bf16_f32 v108, v112, v113
    v_cvt_pk_bf16_f32 v109, v114, v115
    v_exp_f32 v116, v92
    v_exp_f32 v117, v93
    v_exp_f32 v118, v94
    v_exp_f32 v119, v95
    v_mfma_f32_32x32x16_bf16 v[80:95], v[168:171], v[160:163], 0
    v_cvt_pk_bf16_f32 v110, v116, v117
    v_cvt_pk_bf16_f32 v111, v118, v119
    v_exp_f32 v112, v64
    v_exp_f32 v113, v65
    v_exp_f32 v114, v66
    v_exp_f32 v115, v67
    v_mfma_f32_32x32x16_bf16 v[80:95], v[172:175], v[164:167], v[80:95]
    v_cvt_pk_bf16_f32 v96, v112, v113
    v_cvt_pk_bf16_f32 v97, v114, v115
    v_exp_f32 v116, v68
    v_exp_f32 v117, v69
    v_exp_f32 v118, v70
    v_exp_f32 v119, v71
    v_mfma_f32_32x32x16_bf16 v[16:31], v[180:183], v[108:111], v[16:31]
    v_cvt_pk_bf16_f32 v98, v116, v117
    v_cvt_pk_bf16_f32 v99, v118, v119
    v_exp_f32 v112, v72
    v_exp_f32 v113, v73
    v_exp_f32 v114, v74
    v_exp_f32 v115, v75
    v_mfma_f32_32x32x16_bf16 v[32:47], v[176:179], v[96:99], 0
    v_cvt_pk_bf16_f32 v100, v112, v113
    v_cvt_pk_bf16_f32 v101, v114, v115
    v_exp_f32 v116, v76
    v_exp_f32 v117, v77
    v_exp_f32 v118, v78
    v_exp_f32 v119, v79
    s_waitcnt vmcnt(7)
    v_mfma_f32_32x32x16_bf16 v[64:79], v[184:187], v[136:139], 0
    buffer_load_dwordx4 v[216:219], v244, s[44:47], s23 offen offset:0 sc1
    v_cvt_pk_bf16_f32 v102, v116, v117
    v_cvt_pk_bf16_f32 v103, v118, v119
    v_exp_f32 v112, v80
    v_exp_f32 v113, v81
    v_exp_f32 v114, v82
    v_exp_f32 v115, v83
    s_waitcnt vmcnt(7)
    v_mfma_f32_32x32x16_bf16 v[64:79], v[188:191], v[140:143], v[64:79]
    buffer_load_dwordx4 v[220:223], v244, s[44:47], s23 offen offset:1024 sc1
    buffer_store_dwordx4 v[128:131], v244, s[44:47], s8 offen offset:0 sc1
    v_cvt_pk_bf16_f32 v104, v112, v113
    v_cvt_pk_bf16_f32 v105, v114, v115
    v_exp_f32 v116, v84
    v_exp_f32 v117, v85
    v_exp_f32 v118, v86
    v_exp_f32 v119, v87
    v_mfma_f32_32x32x16_bf16 v[32:47], v[180:183], v[100:103], v[32:47]
    buffer_load_dwordx4 v[224:227], v244, s[44:47], s37 offen offset:2048 sc1
    s_waitcnt lgkmcnt(0)
    s_barrier
    ds_read_b128 v[232:235], v120 offset:0
    ds_read_b128 v[236:239], v120 offset:1024
    v_cvt_pk_bf16_f32 v106, v116, v117
    v_cvt_pk_bf16_f32 v107, v118, v119
    v_exp_f32 v112, v88
    v_exp_f32 v113, v89
    v_exp_f32 v114, v90
    v_exp_f32 v115, v91
    v_mfma_f32_32x32x16_bf16 v[48:63], v[176:179], v[104:107], 0
    buffer_load_dwordx4 v[228:231], v244, s[44:47], s37 offen offset:3072 sc1
    v_cvt_pk_bf16_f32 v108, v112, v113
    v_cvt_pk_bf16_f32 v109, v114, v115
    v_exp_f32 v116, v92
    v_exp_f32 v117, v93
    v_exp_f32 v118, v94
    v_exp_f32 v119, v95
    v_mfma_f32_32x32x16_bf16 v[80:95], v[184:187], v[144:147], 0
    v_cvt_pk_bf16_f32 v110, v116, v117
    v_cvt_pk_bf16_f32 v111, v118, v119
    v_exp_f32 v112, v64
    v_exp_f32 v113, v65
    v_exp_f32 v114, v66
    v_exp_f32 v115, v67
    v_mfma_f32_32x32x16_bf16 v[80:95], v[188:191], v[148:151], v[80:95]
    v_cvt_pk_bf16_f32 v96, v112, v113
    v_cvt_pk_bf16_f32 v97, v114, v115
    v_exp_f32 v116, v68
    v_exp_f32 v117, v69
    v_exp_f32 v118, v70
    v_exp_f32 v119, v71
    v_mfma_f32_32x32x16_bf16 v[48:63], v[180:183], v[108:111], v[48:63]
    v_cvt_pk_bf16_f32 v98, v116, v117
    v_cvt_pk_bf16_f32 v99, v118, v119
    v_exp_f32 v112, v72
    v_exp_f32 v113, v73
    v_exp_f32 v114, v74
    v_exp_f32 v115, v75
    s_waitcnt vmcnt(10)
    v_mfma_f32_32x32x16_bf16 v[0:15], v[192:195], v[96:99], v[0:15]
    buffer_load_dwordx4 v[168:171], v244, s[44:47], s24 offen offset:0 sc1
    v_cvt_pk_bf16_f32 v100, v112, v113
    v_cvt_pk_bf16_f32 v101, v114, v115
    v_exp_f32 v116, v76
    v_exp_f32 v117, v77
    v_exp_f32 v118, v78
    v_exp_f32 v119, v79
    v_mfma_f32_32x32x16_bf16 v[64:79], v[184:187], v[152:155], 0
    v_cvt_pk_bf16_f32 v102, v116, v117
    v_cvt_pk_bf16_f32 v103, v118, v119
    v_exp_f32 v112, v80
    v_exp_f32 v113, v81
    v_exp_f32 v114, v82
    v_exp_f32 v115, v83
    v_mfma_f32_32x32x16_bf16 v[64:79], v[188:191], v[156:159], v[64:79]
    v_cvt_pk_bf16_f32 v104, v112, v113
    v_cvt_pk_bf16_f32 v105, v114, v115
    v_exp_f32 v116, v84
    v_exp_f32 v117, v85
    v_exp_f32 v118, v86
    v_exp_f32 v119, v87
    s_waitcnt vmcnt(10)
    v_mfma_f32_32x32x16_bf16 v[0:15], v[196:199], v[100:103], v[0:15]
    v_cvt_pk_bf16_f32 v106, v116, v117
    v_cvt_pk_bf16_f32 v107, v118, v119
    v_exp_f32 v112, v88
    v_exp_f32 v113, v89
    v_exp_f32 v114, v90
    v_exp_f32 v115, v91
    v_mfma_f32_32x32x16_bf16 v[16:31], v[192:195], v[104:107], v[16:31]
    buffer_load_dwordx4 v[172:175], v244, s[44:47], s24 offen offset:1024 sc1
    v_cvt_pk_bf16_f32 v108, v112, v113
    v_cvt_pk_bf16_f32 v109, v114, v115
    v_exp_f32 v116, v92
    v_exp_f32 v117, v93
    v_exp_f32 v118, v94
    v_exp_f32 v119, v95
    v_mfma_f32_32x32x16_bf16 v[80:95], v[184:187], v[160:163], 0
    v_cvt_pk_bf16_f32 v110, v116, v117
    v_cvt_pk_bf16_f32 v111, v118, v119
    v_exp_f32 v112, v64
    v_exp_f32 v113, v65
    v_exp_f32 v114, v66
    v_exp_f32 v115, v67
    v_mfma_f32_32x32x16_bf16 v[80:95], v[188:191], v[164:167], v[80:95]
    v_cvt_pk_bf16_f32 v96, v112, v113
    v_cvt_pk_bf16_f32 v97, v114, v115
    v_exp_f32 v116, v68
    v_exp_f32 v117, v69
    v_exp_f32 v118, v70
    v_exp_f32 v119, v71
    v_mfma_f32_32x32x16_bf16 v[16:31], v[196:199], v[108:111], v[16:31]
    v_cvt_pk_bf16_f32 v98, v116, v117
    v_cvt_pk_bf16_f32 v99, v118, v119
    v_exp_f32 v112, v72
    v_exp_f32 v113, v73
    v_exp_f32 v114, v74
    v_exp_f32 v115, v75
    v_mfma_f32_32x32x16_bf16 v[32:47], v[192:195], v[96:99], v[32:47]
    buffer_load_dwordx4 v[176:179], v244, s[44:47], s38 offen offset:0 sc1
    v_cvt_pk_bf16_f32 v100, v112, v113
    v_cvt_pk_bf16_f32 v101, v114, v115
    v_exp_f32 v116, v76
    v_exp_f32 v117, v77
    v_exp_f32 v118, v78
    v_exp_f32 v119, v79
    s_waitcnt vmcnt(11)
    v_mfma_f32_32x32x16_bf16 v[64:79], v[200:203], v[136:139], 0
    v_cvt_pk_bf16_f32 v102, v116, v117
    v_cvt_pk_bf16_f32 v103, v118, v119
    v_exp_f32 v112, v80
    v_exp_f32 v113, v81
    v_exp_f32 v114, v82
    v_exp_f32 v115, v83
    s_waitcnt vmcnt(10)
    v_mfma_f32_32x32x16_bf16 v[64:79], v[204:207], v[140:143], v[64:79]
    v_cvt_pk_bf16_f32 v104, v112, v113
    v_cvt_pk_bf16_f32 v105, v114, v115
    v_exp_f32 v116, v84
    v_exp_f32 v117, v85
    v_exp_f32 v118, v86
    v_exp_f32 v119, v87
    v_mfma_f32_32x32x16_bf16 v[32:47], v[196:199], v[100:103], v[32:47]
    v_cvt_pk_bf16_f32 v106, v116, v117
    v_cvt_pk_bf16_f32 v107, v118, v119
    v_exp_f32 v112, v88
    v_exp_f32 v113, v89
    v_exp_f32 v114, v90
    v_exp_f32 v115, v91
    v_mfma_f32_32x32x16_bf16 v[48:63], v[192:195], v[104:107], v[48:63]
    buffer_load_dwordx4 v[180:183], v244, s[44:47], s38 offen offset:1024 sc1
    v_cvt_pk_bf16_f32 v108, v112, v113
    v_cvt_pk_bf16_f32 v109, v114, v115
    v_exp_f32 v116, v92
    v_exp_f32 v117, v93
    v_exp_f32 v118, v94
    v_exp_f32 v119, v95
    v_mfma_f32_32x32x16_bf16 v[80:95], v[200:203], v[144:147], 0
    v_cvt_pk_bf16_f32 v110, v116, v117
    v_cvt_pk_bf16_f32 v111, v118, v119
    v_exp_f32 v112, v64
    v_exp_f32 v113, v65
    v_exp_f32 v114, v66
    v_exp_f32 v115, v67
    v_mfma_f32_32x32x16_bf16 v[80:95], v[204:207], v[148:151], v[80:95]
    buffer_store_dwordx4 v[132:135], v244, s[44:47], s8 offen offset:1024 sc1
    v_cvt_pk_bf16_f32 v96, v112, v113
    v_cvt_pk_bf16_f32 v97, v114, v115
    v_exp_f32 v116, v68
    v_exp_f32 v117, v69
    v_exp_f32 v118, v70
    v_exp_f32 v119, v71
    v_mfma_f32_32x32x16_bf16 v[48:63], v[196:199], v[108:111], v[48:63]
    v_cvt_pk_bf16_f32 v98, v116, v117
    v_cvt_pk_bf16_f32 v99, v118, v119
    v_exp_f32 v112, v72
    v_exp_f32 v113, v73
    v_exp_f32 v114, v74
    v_exp_f32 v115, v75
    s_waitcnt vmcnt(11)
    v_mfma_f32_32x32x16_bf16 v[0:15], v[208:211], v[96:99], v[0:15]
    buffer_load_dwordx4 v[184:187], v244, s[44:47], s25 offen offset:0 sc1
    v_cvt_pk_bf16_f32 v100, v112, v113
    v_cvt_pk_bf16_f32 v101, v114, v115
    v_exp_f32 v116, v76
    v_exp_f32 v117, v77
    v_exp_f32 v118, v78
    v_exp_f32 v119, v79
    v_mfma_f32_32x32x16_bf16 v[64:79], v[200:203], v[152:155], 0
    v_cvt_pk_bf16_f32 v102, v116, v117
    v_cvt_pk_bf16_f32 v103, v118, v119
    v_exp_f32 v112, v80
    v_exp_f32 v113, v81
    v_exp_f32 v114, v82
    v_exp_f32 v115, v83
    v_mfma_f32_32x32x16_bf16 v[64:79], v[204:207], v[156:159], v[64:79]
    v_cvt_pk_bf16_f32 v104, v112, v113
    v_cvt_pk_bf16_f32 v105, v114, v115
    v_exp_f32 v116, v84
    v_exp_f32 v117, v85
    v_exp_f32 v118, v86
    v_exp_f32 v119, v87
    s_waitcnt vmcnt(11)
    v_mfma_f32_32x32x16_bf16 v[0:15], v[212:215], v[100:103], v[0:15]
    v_cvt_pk_bf16_f32 v106, v116, v117
    v_cvt_pk_bf16_f32 v107, v118, v119
    v_exp_f32 v112, v88
    v_exp_f32 v113, v89
    v_exp_f32 v114, v90
    v_exp_f32 v115, v91
    v_mfma_f32_32x32x16_bf16 v[16:31], v[208:211], v[104:107], v[16:31]
    buffer_load_dwordx4 v[188:191], v244, s[44:47], s25 offen offset:1024 sc1
    v_cvt_pk_bf16_f32 v108, v112, v113
    v_cvt_pk_bf16_f32 v109, v114, v115
    v_exp_f32 v116, v92
    v_exp_f32 v117, v93
    v_exp_f32 v118, v94
    v_exp_f32 v119, v95
    v_mfma_f32_32x32x16_bf16 v[80:95], v[200:203], v[160:163], 0
    v_cvt_pk_bf16_f32 v110, v116, v117
    v_cvt_pk_bf16_f32 v111, v118, v119
    v_exp_f32 v112, v64
    v_exp_f32 v113, v65
    v_exp_f32 v114, v66
    v_exp_f32 v115, v67
    v_mfma_f32_32x32x16_bf16 v[80:95], v[204:207], v[164:167], v[80:95]
    v_cvt_pk_bf16_f32 v96, v112, v113
    v_cvt_pk_bf16_f32 v97, v114, v115
    v_exp_f32 v116, v68
    v_exp_f32 v117, v69
    v_exp_f32 v118, v70
    v_exp_f32 v119, v71
    v_mfma_f32_32x32x16_bf16 v[16:31], v[212:215], v[108:111], v[16:31]
    v_cvt_pk_bf16_f32 v98, v116, v117
    v_cvt_pk_bf16_f32 v99, v118, v119
    v_exp_f32 v112, v72
    v_exp_f32 v113, v73
    v_exp_f32 v114, v74
    v_exp_f32 v115, v75
    v_mfma_f32_32x32x16_bf16 v[32:47], v[208:211], v[96:99], v[32:47]
    buffer_load_dwordx4 v[192:195], v244, s[44:47], s38 offen offset:2048 sc1
    v_cvt_pk_bf16_f32 v100, v112, v113
    v_cvt_pk_bf16_f32 v101, v114, v115
    v_exp_f32 v116, v76
    v_exp_f32 v117, v77
    v_exp_f32 v118, v78
    v_exp_f32 v119, v79
    s_waitcnt vmcnt(8)
    v_mfma_f32_32x32x16_bf16 v[64:79], v[216:219], v[136:139], 0
    v_cvt_pk_bf16_f32 v102, v116, v117
    v_cvt_pk_bf16_f32 v103, v118, v119
    v_exp_f32 v112, v80
    v_exp_f32 v113, v81
    v_exp_f32 v114, v82
    v_exp_f32 v115, v83
    v_mfma_f32_32x32x16_bf16 v[64:79], v[220:223], v[140:143], v[64:79]
    v_cvt_pk_bf16_f32 v104, v112, v113
    v_cvt_pk_bf16_f32 v105, v114, v115
    v_exp_f32 v116, v84
    v_exp_f32 v117, v85
    v_exp_f32 v118, v86
    v_exp_f32 v119, v87
    v_mfma_f32_32x32x16_bf16 v[32:47], v[212:215], v[100:103], v[32:47]
    v_cvt_pk_bf16_f32 v106, v116, v117
    v_cvt_pk_bf16_f32 v107, v118, v119
    v_exp_f32 v112, v88
    v_exp_f32 v113, v89
    v_exp_f32 v114, v90
    v_exp_f32 v115, v91
    v_mfma_f32_32x32x16_bf16 v[48:63], v[208:211], v[104:107], v[48:63]
    buffer_load_dwordx4 v[196:199], v244, s[44:47], s38 offen offset:3072 sc1
    v_cvt_pk_bf16_f32 v108, v112, v113
    v_cvt_pk_bf16_f32 v109, v114, v115
    v_exp_f32 v116, v92
    v_exp_f32 v117, v93
    v_exp_f32 v118, v94
    v_exp_f32 v119, v95
    v_mfma_f32_32x32x16_bf16 v[80:95], v[216:219], v[144:147], 0
    v_cvt_pk_bf16_f32 v110, v116, v117
    v_cvt_pk_bf16_f32 v111, v118, v119
    v_exp_f32 v112, v64
    v_exp_f32 v113, v65
    v_exp_f32 v114, v66
    v_exp_f32 v115, v67
    v_mfma_f32_32x32x16_bf16 v[80:95], v[220:223], v[148:151], v[80:95]
    v_cvt_pk_bf16_f32 v96, v112, v113
    v_cvt_pk_bf16_f32 v97, v114, v115
    v_exp_f32 v116, v68
    v_exp_f32 v117, v69
    v_exp_f32 v118, v70
    v_exp_f32 v119, v71
    v_mfma_f32_32x32x16_bf16 v[48:63], v[212:215], v[108:111], v[48:63]
    v_cvt_pk_bf16_f32 v98, v116, v117
    v_cvt_pk_bf16_f32 v99, v118, v119
    v_exp_f32 v112, v72
    v_exp_f32 v113, v73
    v_exp_f32 v114, v74
    v_exp_f32 v115, v75
    v_mfma_f32_32x32x16_bf16 v[0:15], v[224:227], v[96:99], v[0:15]
    buffer_load_dwordx4 v[200:203], v244, s[44:47], s26 offen offset:0 sc1
    v_cvt_pk_bf16_f32 v100, v112, v113
    v_cvt_pk_bf16_f32 v101, v114, v115
    v_exp_f32 v116, v76
    v_exp_f32 v117, v77
    v_exp_f32 v118, v78
    v_exp_f32 v119, v79
    v_mfma_f32_32x32x16_bf16 v[64:79], v[216:219], v[152:155], 0
    v_cvt_pk_bf16_f32 v102, v116, v117
    v_cvt_pk_bf16_f32 v103, v118, v119
    v_exp_f32 v112, v80
    v_exp_f32 v113, v81
    v_exp_f32 v114, v82
    v_exp_f32 v115, v83
    v_mfma_f32_32x32x16_bf16 v[64:79], v[220:223], v[156:159], v[64:79]
    s_waitcnt lgkmcnt(1)
    buffer_store_dwordx4 v[232:235], v244, s[44:47], s8 offen offset:2048 sc1
    v_cvt_pk_bf16_f32 v104, v112, v113
    v_cvt_pk_bf16_f32 v105, v114, v115
    v_exp_f32 v116, v84
    v_exp_f32 v117, v85
    v_exp_f32 v118, v86
    v_exp_f32 v119, v87
    v_mfma_f32_32x32x16_bf16 v[0:15], v[228:231], v[100:103], v[0:15]
    v_cvt_pk_bf16_f32 v106, v116, v117
    v_cvt_pk_bf16_f32 v107, v118, v119
    v_exp_f32 v112, v88
    v_exp_f32 v113, v89
    v_exp_f32 v114, v90
    v_exp_f32 v115, v91
    v_mfma_f32_32x32x16_bf16 v[16:31], v[224:227], v[104:107], v[16:31]
    buffer_load_dwordx4 v[204:207], v244, s[44:47], s26 offen offset:1024 sc1
    v_cvt_pk_bf16_f32 v108, v112, v113
    v_cvt_pk_bf16_f32 v109, v114, v115
    v_exp_f32 v116, v92
    v_exp_f32 v117, v93
    v_exp_f32 v118, v94
    v_exp_f32 v119, v95
    v_mfma_f32_32x32x16_bf16 v[80:95], v[216:219], v[160:163], 0
    v_cvt_pk_bf16_f32 v110, v116, v117
    v_cvt_pk_bf16_f32 v111, v118, v119
    v_exp_f32 v112, v64
    v_exp_f32 v113, v65
    v_exp_f32 v114, v66
    v_exp_f32 v115, v67
    v_mfma_f32_32x32x16_bf16 v[80:95], v[220:223], v[164:167], v[80:95]
    v_cvt_pk_bf16_f32 v96, v112, v113
    v_cvt_pk_bf16_f32 v97, v114, v115
    v_exp_f32 v116, v68
    v_exp_f32 v117, v69
    v_exp_f32 v118, v70
    v_exp_f32 v119, v71
    v_mfma_f32_32x32x16_bf16 v[16:31], v[228:231], v[108:111], v[16:31]
    v_cvt_pk_bf16_f32 v98, v116, v117
    v_cvt_pk_bf16_f32 v99, v118, v119
    v_exp_f32 v112, v72
    v_exp_f32 v113, v73
    v_exp_f32 v114, v74
    v_exp_f32 v115, v75
    v_mfma_f32_32x32x16_bf16 v[32:47], v[224:227], v[96:99], v[32:47]
    buffer_load_dwordx4 v[208:211], v244, s[44:47], s39 offen offset:0 sc1
    v_cvt_pk_bf16_f32 v100, v112, v113
    v_cvt_pk_bf16_f32 v101, v114, v115
    v_exp_f32 v116, v76
    v_exp_f32 v117, v77
    v_exp_f32 v118, v78
    v_exp_f32 v119, v79
    s_waitcnt vmcnt(9)
    v_mfma_f32_32x32x16_bf16 v[64:79], v[168:171], v[136:139], 0
    v_cvt_pk_bf16_f32 v102, v116, v117
    v_cvt_pk_bf16_f32 v103, v118, v119
    v_exp_f32 v112, v80
    v_exp_f32 v113, v81
    v_exp_f32 v114, v82
    v_exp_f32 v115, v83
    v_mfma_f32_32x32x16_bf16 v[64:79], v[172:175], v[140:143], v[64:79]
    v_cvt_pk_bf16_f32 v104, v112, v113
    v_cvt_pk_bf16_f32 v105, v114, v115
    v_exp_f32 v116, v84
    v_exp_f32 v117, v85
    v_exp_f32 v118, v86
    v_exp_f32 v119, v87
    v_mfma_f32_32x32x16_bf16 v[32:47], v[228:231], v[100:103], v[32:47]
    v_cvt_pk_bf16_f32 v106, v116, v117
    v_cvt_pk_bf16_f32 v107, v118, v119
    v_exp_f32 v112, v88
    v_exp_f32 v113, v89
    v_exp_f32 v114, v90
    v_exp_f32 v115, v91
    v_mfma_f32_32x32x16_bf16 v[48:63], v[224:227], v[104:107], v[48:63]
    buffer_load_dwordx4 v[212:215], v244, s[44:47], s39 offen offset:1024 sc1
    v_cvt_pk_bf16_f32 v108, v112, v113
    v_cvt_pk_bf16_f32 v109, v114, v115
    v_exp_f32 v116, v92
    v_exp_f32 v117, v93
    v_exp_f32 v118, v94
    v_exp_f32 v119, v95
    v_mfma_f32_32x32x16_bf16 v[80:95], v[168:171], v[144:147], 0
    v_cvt_pk_bf16_f32 v110, v116, v117
    v_cvt_pk_bf16_f32 v111, v118, v119
    v_exp_f32 v112, v64
    v_exp_f32 v113, v65
    v_exp_f32 v114, v66
    v_exp_f32 v115, v67
    v_mfma_f32_32x32x16_bf16 v[80:95], v[172:175], v[148:151], v[80:95]
    v_cvt_pk_bf16_f32 v96, v112, v113
    v_cvt_pk_bf16_f32 v97, v114, v115
    v_exp_f32 v116, v68
    v_exp_f32 v117, v69
    v_exp_f32 v118, v70
    v_exp_f32 v119, v71
    v_mfma_f32_32x32x16_bf16 v[48:63], v[228:231], v[108:111], v[48:63]
    v_cvt_pk_bf16_f32 v98, v116, v117
    v_cvt_pk_bf16_f32 v99, v118, v119
    v_exp_f32 v112, v72
    v_exp_f32 v113, v73
    v_exp_f32 v114, v74
    v_exp_f32 v115, v75
    v_mfma_f32_32x32x16_bf16 v[0:15], v[176:179], v[96:99], v[0:15]
    buffer_load_dwordx4 v[216:219], v244, s[44:47], s27 offen offset:0 sc1
    v_cvt_pk_bf16_f32 v100, v112, v113
    v_cvt_pk_bf16_f32 v101, v114, v115
    v_exp_f32 v116, v76
    v_exp_f32 v117, v77
    v_exp_f32 v118, v78
    v_exp_f32 v119, v79
    v_mfma_f32_32x32x16_bf16 v[64:79], v[168:171], v[152:155], 0
    v_cvt_pk_bf16_f32 v102, v116, v117
    v_cvt_pk_bf16_f32 v103, v118, v119
    v_exp_f32 v112, v80
    v_exp_f32 v113, v81
    v_exp_f32 v114, v82
    v_exp_f32 v115, v83
    v_mfma_f32_32x32x16_bf16 v[64:79], v[172:175], v[156:159], v[64:79]
    v_cvt_pk_bf16_f32 v104, v112, v113
    v_cvt_pk_bf16_f32 v105, v114, v115
    v_exp_f32 v116, v84
    v_exp_f32 v117, v85
    v_exp_f32 v118, v86
    v_exp_f32 v119, v87
    v_mfma_f32_32x32x16_bf16 v[0:15], v[180:183], v[100:103], v[0:15]
    v_cvt_pk_bf16_f32 v106, v116, v117
    v_cvt_pk_bf16_f32 v107, v118, v119
    v_exp_f32 v112, v88
    v_exp_f32 v113, v89
    v_exp_f32 v114, v90
    v_exp_f32 v115, v91
    v_mfma_f32_32x32x16_bf16 v[16:31], v[176:179], v[104:107], v[16:31]
    buffer_load_dwordx4 v[220:223], v244, s[44:47], s27 offen offset:1024 sc1
    v_cvt_pk_bf16_f32 v108, v112, v113
    v_cvt_pk_bf16_f32 v109, v114, v115
    v_exp_f32 v116, v92
    v_exp_f32 v117, v93
    v_exp_f32 v118, v94
    v_exp_f32 v119, v95
    v_mfma_f32_32x32x16_bf16 v[80:95], v[168:171], v[160:163], 0
    v_cvt_pk_bf16_f32 v110, v116, v117
    v_cvt_pk_bf16_f32 v111, v118, v119
    v_exp_f32 v112, v64
    v_exp_f32 v113, v65
    v_exp_f32 v114, v66
    v_exp_f32 v115, v67
    v_mfma_f32_32x32x16_bf16 v[80:95], v[172:175], v[164:167], v[80:95]
    s_waitcnt lgkmcnt(0)
    buffer_store_dwordx4 v[236:239], v244, s[44:47], s8 offen offset:3072 sc1
    v_cvt_pk_bf16_f32 v96, v112, v113
    v_cvt_pk_bf16_f32 v97, v114, v115
    v_exp_f32 v116, v68
    v_exp_f32 v117, v69
    v_exp_f32 v118, v70
    v_exp_f32 v119, v71
    v_mfma_f32_32x32x16_bf16 v[16:31], v[180:183], v[108:111], v[16:31]
    v_cvt_pk_bf16_f32 v98, v116, v117
    v_cvt_pk_bf16_f32 v99, v118, v119
    v_exp_f32 v112, v72
    v_exp_f32 v113, v73
    v_exp_f32 v114, v74
    v_exp_f32 v115, v75
    v_mfma_f32_32x32x16_bf16 v[32:47], v[176:179], v[96:99], v[32:47]
    buffer_load_dwordx4 v[224:227], v244, s[44:47], s39 offen offset:2048 sc1
    v_cvt_pk_bf16_f32 v100, v112, v113
    v_cvt_pk_bf16_f32 v101, v114, v115
    v_exp_f32 v116, v76
    v_exp_f32 v117, v77
    v_exp_f32 v118, v78
    v_exp_f32 v119, v79
    s_waitcnt vmcnt(9)
    v_mfma_f32_32x32x16_bf16 v[64:79], v[184:187], v[136:139], 0
    v_cvt_pk_bf16_f32 v102, v116, v117
    v_cvt_pk_bf16_f32 v103, v118, v119
    v_exp_f32 v112, v80
    v_exp_f32 v113, v81
    v_exp_f32 v114, v82
    v_exp_f32 v115, v83
    v_mfma_f32_32x32x16_bf16 v[64:79], v[188:191], v[140:143], v[64:79]
    v_cvt_pk_bf16_f32 v104, v112, v113
    v_cvt_pk_bf16_f32 v105, v114, v115
    v_exp_f32 v116, v84
    v_exp_f32 v117, v85
    v_exp_f32 v118, v86
    v_exp_f32 v119, v87
    v_mfma_f32_32x32x16_bf16 v[32:47], v[180:183], v[100:103], v[32:47]
    v_cvt_pk_bf16_f32 v106, v116, v117
    v_cvt_pk_bf16_f32 v107, v118, v119
    v_exp_f32 v112, v88
    v_exp_f32 v113, v89
    v_exp_f32 v114, v90
    v_exp_f32 v115, v91
    v_mfma_f32_32x32x16_bf16 v[48:63], v[176:179], v[104:107], v[48:63]
    buffer_load_dwordx4 v[228:231], v244, s[44:47], s39 offen offset:3072 sc1
    v_cvt_pk_bf16_f32 v108, v112, v113
    v_cvt_pk_bf16_f32 v109, v114, v115
    v_exp_f32 v116, v92
    v_exp_f32 v117, v93
    v_exp_f32 v118, v94
    v_exp_f32 v119, v95
    v_mfma_f32_32x32x16_bf16 v[80:95], v[184:187], v[144:147], 0
    v_cvt_pk_bf16_f32 v110, v116, v117
    v_cvt_pk_bf16_f32 v111, v118, v119
    v_exp_f32 v112, v64
    v_exp_f32 v113, v65
    v_exp_f32 v114, v66
    v_exp_f32 v115, v67
    v_mfma_f32_32x32x16_bf16 v[80:95], v[188:191], v[148:151], v[80:95]
    v_cvt_pk_bf16_f32 v96, v112, v113
    v_cvt_pk_bf16_f32 v97, v114, v115
    v_exp_f32 v116, v68
    v_exp_f32 v117, v69
    v_exp_f32 v118, v70
    v_exp_f32 v119, v71
    v_mfma_f32_32x32x16_bf16 v[48:63], v[180:183], v[108:111], v[48:63]
    v_cvt_pk_bf16_f32 v98, v116, v117
    v_cvt_pk_bf16_f32 v99, v118, v119
    v_exp_f32 v112, v72
    v_exp_f32 v113, v73
    v_exp_f32 v114, v74
    v_exp_f32 v115, v75
    v_mfma_f32_32x32x16_bf16 v[0:15], v[192:195], v[96:99], v[0:15]
    buffer_load_dwordx4 v[168:171], v244, s[44:47], s28 offen offset:0 sc1
    v_cvt_pk_bf16_f32 v100, v112, v113
    v_cvt_pk_bf16_f32 v101, v114, v115
    v_exp_f32 v116, v76
    v_exp_f32 v117, v77
    v_exp_f32 v118, v78
    v_exp_f32 v119, v79
    v_mfma_f32_32x32x16_bf16 v[64:79], v[184:187], v[152:155], 0
    v_cvt_pk_bf16_f32 v102, v116, v117
    v_cvt_pk_bf16_f32 v103, v118, v119
    v_exp_f32 v112, v80
    v_exp_f32 v113, v81
    v_exp_f32 v114, v82
    v_exp_f32 v115, v83
    v_mfma_f32_32x32x16_bf16 v[64:79], v[188:191], v[156:159], v[64:79]
    v_cvt_pk_bf16_f32 v104, v112, v113
    v_cvt_pk_bf16_f32 v105, v114, v115
    v_exp_f32 v116, v84
    v_exp_f32 v117, v85
    v_exp_f32 v118, v86
    v_exp_f32 v119, v87
    v_mfma_f32_32x32x16_bf16 v[0:15], v[196:199], v[100:103], v[0:15]
    v_cvt_pk_bf16_f32 v106, v116, v117
    v_cvt_pk_bf16_f32 v107, v118, v119
    v_exp_f32 v112, v88
    v_exp_f32 v113, v89
    v_exp_f32 v114, v90
    v_exp_f32 v115, v91
    v_mfma_f32_32x32x16_bf16 v[16:31], v[192:195], v[104:107], v[16:31]
    buffer_load_dwordx4 v[172:175], v244, s[44:47], s28 offen offset:1024 sc1
    v_cvt_pk_bf16_f32 v108, v112, v113
    v_cvt_pk_bf16_f32 v109, v114, v115
    v_exp_f32 v116, v92
    v_exp_f32 v117, v93
    v_exp_f32 v118, v94
    v_exp_f32 v119, v95
    v_mfma_f32_32x32x16_bf16 v[80:95], v[184:187], v[160:163], 0
    v_cvt_pk_bf16_f32 v110, v116, v117
    v_cvt_pk_bf16_f32 v111, v118, v119
    v_exp_f32 v112, v64
    v_exp_f32 v113, v65
    v_exp_f32 v114, v66
    v_exp_f32 v115, v67
    v_mfma_f32_32x32x16_bf16 v[80:95], v[188:191], v[164:167], v[80:95]
    v_cvt_pk_bf16_f32 v96, v112, v113
    v_cvt_pk_bf16_f32 v97, v114, v115
    v_exp_f32 v116, v68
    v_exp_f32 v117, v69
    v_exp_f32 v118, v70
    v_exp_f32 v119, v71
    v_mfma_f32_32x32x16_bf16 v[16:31], v[196:199], v[108:111], v[16:31]
    v_cvt_pk_bf16_f32 v98, v116, v117
    v_cvt_pk_bf16_f32 v99, v118, v119
    v_exp_f32 v112, v72
    v_exp_f32 v113, v73
    v_exp_f32 v114, v74
    v_exp_f32 v115, v75
    v_mfma_f32_32x32x16_bf16 v[32:47], v[192:195], v[96:99], v[32:47]
    buffer_load_dwordx4 v[176:179], v244, s[44:47], s40 offen offset:0 sc1
    v_cvt_pk_bf16_f32 v100, v112, v113
    v_cvt_pk_bf16_f32 v101, v114, v115
    v_exp_f32 v116, v76
    v_exp_f32 v117, v77
    v_exp_f32 v118, v78
    v_exp_f32 v119, v79
    s_waitcnt vmcnt(8)
    v_mfma_f32_32x32x16_bf16 v[64:79], v[200:203], v[136:139], 0
    v_cvt_pk_bf16_f32 v102, v116, v117
    v_cvt_pk_bf16_f32 v103, v118, v119
    v_exp_f32 v112, v80
    v_exp_f32 v113, v81
    v_exp_f32 v114, v82
    v_exp_f32 v115, v83
    v_mfma_f32_32x32x16_bf16 v[64:79], v[204:207], v[140:143], v[64:79]
    v_cvt_pk_bf16_f32 v104, v112, v113
    v_cvt_pk_bf16_f32 v105, v114, v115
    v_exp_f32 v116, v84
    v_exp_f32 v117, v85
    v_exp_f32 v118, v86
    v_exp_f32 v119, v87
    v_mfma_f32_32x32x16_bf16 v[32:47], v[196:199], v[100:103], v[32:47]
    v_cvt_pk_bf16_f32 v106, v116, v117
    v_cvt_pk_bf16_f32 v107, v118, v119
    v_exp_f32 v112, v88
    v_exp_f32 v113, v89
    v_exp_f32 v114, v90
    v_exp_f32 v115, v91
    v_mfma_f32_32x32x16_bf16 v[48:63], v[192:195], v[104:107], v[48:63]
    buffer_load_dwordx4 v[180:183], v244, s[44:47], s40 offen offset:1024 sc1
    v_cvt_pk_bf16_f32 v108, v112, v113
    v_cvt_pk_bf16_f32 v109, v114, v115
    v_exp_f32 v116, v92
    v_exp_f32 v117, v93
    v_exp_f32 v118, v94
    v_exp_f32 v119, v95
    v_mfma_f32_32x32x16_bf16 v[80:95], v[200:203], v[144:147], 0
    v_cvt_pk_bf16_f32 v110, v116, v117
    v_cvt_pk_bf16_f32 v111, v118, v119
    v_exp_f32 v112, v64
    v_exp_f32 v113, v65
    v_exp_f32 v114, v66
    v_exp_f32 v115, v67
    v_mfma_f32_32x32x16_bf16 v[80:95], v[204:207], v[148:151], v[80:95]
    v_cvt_pk_bf16_f32 v96, v112, v113
    v_cvt_pk_bf16_f32 v97, v114, v115
    v_exp_f32 v116, v68
    v_exp_f32 v117, v69
    v_exp_f32 v118, v70
    v_exp_f32 v119, v71
    v_mfma_f32_32x32x16_bf16 v[48:63], v[196:199], v[108:111], v[48:63]
    v_cvt_pk_bf16_f32 v98, v116, v117
    v_cvt_pk_bf16_f32 v99, v118, v119
    v_exp_f32 v112, v72
    v_exp_f32 v113, v73
    v_exp_f32 v114, v74
    v_exp_f32 v115, v75
    v_mfma_f32_32x32x16_bf16 v[0:15], v[208:211], v[96:99], v[0:15]
    buffer_load_dwordx4 v[184:187], v244, s[44:47], s29 offen offset:0 sc1
    v_cvt_pk_bf16_f32 v100, v112, v113
    v_cvt_pk_bf16_f32 v101, v114, v115
    v_exp_f32 v116, v76
    v_exp_f32 v117, v77
    v_exp_f32 v118, v78
    v_exp_f32 v119, v79
    v_mfma_f32_32x32x16_bf16 v[64:79], v[200:203], v[152:155], 0
    v_cvt_pk_bf16_f32 v102, v116, v117
    v_cvt_pk_bf16_f32 v103, v118, v119
    v_exp_f32 v112, v80
    v_exp_f32 v113, v81
    v_exp_f32 v114, v82
    v_exp_f32 v115, v83
    v_mfma_f32_32x32x16_bf16 v[64:79], v[204:207], v[156:159], v[64:79]
    v_cvt_pk_bf16_f32 v104, v112, v113
    v_cvt_pk_bf16_f32 v105, v114, v115
    v_exp_f32 v116, v84
    v_exp_f32 v117, v85
    v_exp_f32 v118, v86
    v_exp_f32 v119, v87
    v_mfma_f32_32x32x16_bf16 v[0:15], v[212:215], v[100:103], v[0:15]
    v_cvt_pk_bf16_f32 v106, v116, v117
    v_cvt_pk_bf16_f32 v107, v118, v119
    v_exp_f32 v112, v88
    v_exp_f32 v113, v89
    v_exp_f32 v114, v90
    v_exp_f32 v115, v91
    v_mfma_f32_32x32x16_bf16 v[16:31], v[208:211], v[104:107], v[16:31]
    buffer_load_dwordx4 v[188:191], v244, s[44:47], s29 offen offset:1024 sc1
    v_cvt_pk_bf16_f32 v108, v112, v113
    v_cvt_pk_bf16_f32 v109, v114, v115
    v_exp_f32 v116, v92
    v_exp_f32 v117, v93
    v_exp_f32 v118, v94
    v_exp_f32 v119, v95
    v_mfma_f32_32x32x16_bf16 v[80:95], v[200:203], v[160:163], 0
    v_cvt_pk_bf16_f32 v110, v116, v117
    v_cvt_pk_bf16_f32 v111, v118, v119
    v_exp_f32 v112, v64
    v_exp_f32 v113, v65
    v_exp_f32 v114, v66
    v_exp_f32 v115, v67
    v_mfma_f32_32x32x16_bf16 v[80:95], v[204:207], v[164:167], v[80:95]
    v_cvt_pk_bf16_f32 v96, v112, v113
    v_cvt_pk_bf16_f32 v97, v114, v115
    v_exp_f32 v116, v68
    v_exp_f32 v117, v69
    v_exp_f32 v118, v70
    v_exp_f32 v119, v71
    v_mfma_f32_32x32x16_bf16 v[16:31], v[212:215], v[108:111], v[16:31]
    v_cvt_pk_bf16_f32 v98, v116, v117
    v_cvt_pk_bf16_f32 v99, v118, v119
    v_exp_f32 v112, v72
    v_exp_f32 v113, v73
    v_exp_f32 v114, v74
    v_exp_f32 v115, v75
    v_mfma_f32_32x32x16_bf16 v[32:47], v[208:211], v[96:99], v[32:47]
    buffer_load_dwordx4 v[192:195], v244, s[44:47], s40 offen offset:2048 sc1
    v_cvt_pk_bf16_f32 v100, v112, v113
    v_cvt_pk_bf16_f32 v101, v114, v115
    v_exp_f32 v116, v76
    v_exp_f32 v117, v77
    v_exp_f32 v118, v78
    v_exp_f32 v119, v79
    s_waitcnt vmcnt(7)
    v_mfma_f32_32x32x16_bf16 v[64:79], v[216:219], v[136:139], 0
    v_cvt_pk_bf16_f32 v102, v116, v117
    v_cvt_pk_bf16_f32 v103, v118, v119
    v_exp_f32 v112, v80
    v_exp_f32 v113, v81
    v_exp_f32 v114, v82
    v_exp_f32 v115, v83
    v_mfma_f32_32x32x16_bf16 v[64:79], v[220:223], v[140:143], v[64:79]
    v_cvt_pk_bf16_f32 v104, v112, v113
    v_cvt_pk_bf16_f32 v105, v114, v115
    v_exp_f32 v116, v84
    v_exp_f32 v117, v85
    v_exp_f32 v118, v86
    v_exp_f32 v119, v87
    v_mfma_f32_32x32x16_bf16 v[32:47], v[212:215], v[100:103], v[32:47]
    v_cvt_pk_bf16_f32 v106, v116, v117
    v_cvt_pk_bf16_f32 v107, v118, v119
    v_exp_f32 v112, v88
    v_exp_f32 v113, v89
    v_exp_f32 v114, v90
    v_exp_f32 v115, v91
    v_mfma_f32_32x32x16_bf16 v[48:63], v[208:211], v[104:107], v[48:63]
    buffer_load_dwordx4 v[196:199], v244, s[44:47], s40 offen offset:3072 sc1
    v_cvt_pk_bf16_f32 v108, v112, v113
    v_cvt_pk_bf16_f32 v109, v114, v115
    v_exp_f32 v116, v92
    v_exp_f32 v117, v93
    v_exp_f32 v118, v94
    v_exp_f32 v119, v95
    v_mfma_f32_32x32x16_bf16 v[80:95], v[216:219], v[144:147], 0
    s_mov_b64 exec, 1
    buffer_store_dword v246, v244, s[44:47], s10 offen sc1
    s_mov_b64 exec, -1
    v_cvt_pk_bf16_f32 v110, v116, v117
    v_cvt_pk_bf16_f32 v111, v118, v119
    v_exp_f32 v112, v64
    v_exp_f32 v113, v65
    v_exp_f32 v114, v66
    v_exp_f32 v115, v67
    v_mfma_f32_32x32x16_bf16 v[80:95], v[220:223], v[148:151], v[80:95]
    v_cvt_pk_bf16_f32 v96, v112, v113
    v_cvt_pk_bf16_f32 v97, v114, v115
    v_exp_f32 v116, v68
    v_exp_f32 v117, v69
    v_exp_f32 v118, v70
    v_exp_f32 v119, v71
    v_mfma_f32_32x32x16_bf16 v[48:63], v[212:215], v[108:111], v[48:63]
    v_cvt_pk_bf16_f32 v98, v116, v117
    v_cvt_pk_bf16_f32 v99, v118, v119
    v_exp_f32 v112, v72
    v_exp_f32 v113, v73
    v_exp_f32 v114, v74
    v_exp_f32 v115, v75
    v_mfma_f32_32x32x16_bf16 v[0:15], v[224:227], v[96:99], v[0:15]
    buffer_load_dwordx4 v[200:203], v244, s[44:47], s30 offen offset:0 sc1
    v_cvt_pk_bf16_f32 v100, v112, v113
    v_cvt_pk_bf16_f32 v101, v114, v115
    v_exp_f32 v116, v76
    v_exp_f32 v117, v77
    v_exp_f32 v118, v78
    v_exp_f32 v119, v79
    v_mfma_f32_32x32x16_bf16 v[64:79], v[216:219], v[152:155], 0
    v_cvt_pk_bf16_f32 v102, v116, v117
    v_cvt_pk_bf16_f32 v103, v118, v119
    v_exp_f32 v112, v80
    v_exp_f32 v113, v81
    v_exp_f32 v114, v82
    v_exp_f32 v115, v83
    v_mfma_f32_32x32x16_bf16 v[64:79], v[220:223], v[156:159], v[64:79]
    v_cvt_pk_bf16_f32 v104, v112, v113
    v_cvt_pk_bf16_f32 v105, v114, v115
    v_exp_f32 v116, v84
    v_exp_f32 v117, v85
    v_exp_f32 v118, v86
    v_exp_f32 v119, v87
    v_mfma_f32_32x32x16_bf16 v[0:15], v[228:231], v[100:103], v[0:15]
    v_cvt_pk_bf16_f32 v106, v116, v117
    v_cvt_pk_bf16_f32 v107, v118, v119
    v_exp_f32 v112, v88
    v_exp_f32 v113, v89
    v_exp_f32 v114, v90
    v_exp_f32 v115, v91
    v_mfma_f32_32x32x16_bf16 v[16:31], v[224:227], v[104:107], v[16:31]
    buffer_load_dwordx4 v[204:207], v244, s[44:47], s30 offen offset:1024 sc1
    v_cvt_pk_bf16_f32 v108, v112, v113
    v_cvt_pk_bf16_f32 v109, v114, v115
    v_exp_f32 v116, v92
    v_exp_f32 v117, v93
    v_exp_f32 v118, v94
    v_exp_f32 v119, v95
    v_mfma_f32_32x32x16_bf16 v[80:95], v[216:219], v[160:163], 0
    v_cvt_pk_bf16_f32 v110, v116, v117
    v_cvt_pk_bf16_f32 v111, v118, v119
    v_exp_f32 v112, v64
    v_exp_f32 v113, v65
    v_exp_f32 v114, v66
    v_exp_f32 v115, v67
    v_mfma_f32_32x32x16_bf16 v[80:95], v[220:223], v[164:167], v[80:95]
    v_cvt_pk_bf16_f32 v96, v112, v113
    v_cvt_pk_bf16_f32 v97, v114, v115
    v_exp_f32 v116, v68
    v_exp_f32 v117, v69
    v_exp_f32 v118, v70
    v_exp_f32 v119, v71
    v_mfma_f32_32x32x16_bf16 v[16:31], v[228:231], v[108:111], v[16:31]
    v_cvt_pk_bf16_f32 v98, v116, v117
    v_cvt_pk_bf16_f32 v99, v118, v119
    v_exp_f32 v112, v72
    v_exp_f32 v113, v73
    v_exp_f32 v114, v74
    v_exp_f32 v115, v75
    v_mfma_f32_32x32x16_bf16 v[32:47], v[224:227], v[96:99], v[32:47]
    buffer_load_dwordx4 v[208:211], v244, s[44:47], s41 offen offset:0 sc1
    v_cvt_pk_bf16_f32 v100, v112, v113
    v_cvt_pk_bf16_f32 v101, v114, v115
    v_exp_f32 v116, v76
    v_exp_f32 v117, v77
    v_exp_f32 v118, v78
    v_exp_f32 v119, v79
    s_waitcnt vmcnt(8)
    v_mfma_f32_32x32x16_bf16 v[64:79], v[168:171], v[136:139], 0
    v_cvt_pk_bf16_f32 v102, v116, v117
    v_cvt_pk_bf16_f32 v103, v118, v119
    v_exp_f32 v112, v80
    v_exp_f32 v113, v81
    v_exp_f32 v114, v82
    v_exp_f32 v115, v83
    v_mfma_f32_32x32x16_bf16 v[64:79], v[172:175], v[140:143], v[64:79]
    v_cvt_pk_bf16_f32 v104, v112, v113
    v_cvt_pk_bf16_f32 v105, v114, v115
    v_exp_f32 v116, v84
    v_exp_f32 v117, v85
    v_exp_f32 v118, v86
    v_exp_f32 v119, v87
    v_mfma_f32_32x32x16_bf16 v[32:47], v[228:231], v[100:103], v[32:47]
    v_cvt_pk_bf16_f32 v106, v116, v117
    v_cvt_pk_bf16_f32 v107, v118, v119
    v_exp_f32 v112, v88
    v_exp_f32 v113, v89
    v_exp_f32 v114, v90
    v_exp_f32 v115, v91
    v_mfma_f32_32x32x16_bf16 v[48:63], v[224:227], v[104:107], v[48:63]
    buffer_load_dwordx4 v[212:215], v244, s[44:47], s41 offen offset:1024 sc1
    v_cvt_pk_bf16_f32 v108, v112, v113
    v_cvt_pk_bf16_f32 v109, v114, v115
    v_exp_f32 v116, v92
    v_exp_f32 v117, v93
    v_exp_f32 v118, v94
    v_exp_f32 v119, v95
    v_mfma_f32_32x32x16_bf16 v[80:95], v[168:171], v[144:147], 0
    v_cvt_pk_bf16_f32 v110, v116, v117
    v_cvt_pk_bf16_f32 v111, v118, v119
    v_exp_f32 v112, v64
    v_exp_f32 v113, v65
    v_exp_f32 v114, v66
    v_exp_f32 v115, v67
    v_mfma_f32_32x32x16_bf16 v[80:95], v[172:175], v[148:151], v[80:95]
    v_cvt_pk_bf16_f32 v96, v112, v113
    v_cvt_pk_bf16_f32 v97, v114, v115
    v_exp_f32 v116, v68
    v_exp_f32 v117, v69
    v_exp_f32 v118, v70
    v_exp_f32 v119, v71
    v_mfma_f32_32x32x16_bf16 v[48:63], v[228:231], v[108:111], v[48:63]
    v_cvt_pk_bf16_f32 v98, v116, v117
    v_cvt_pk_bf16_f32 v99, v118, v119
    v_exp_f32 v112, v72
    v_exp_f32 v113, v73
    v_exp_f32 v114, v74
    v_exp_f32 v115, v75
    v_mfma_f32_32x32x16_bf16 v[0:15], v[176:179], v[96:99], v[0:15]
    buffer_load_dwordx4 v[216:219], v244, s[44:47], s31 offen offset:0 sc1
    v_cvt_pk_bf16_f32 v100, v112, v113
    v_cvt_pk_bf16_f32 v101, v114, v115
    v_exp_f32 v116, v76
    v_exp_f32 v117, v77
    v_exp_f32 v118, v78
    v_exp_f32 v119, v79
    v_mfma_f32_32x32x16_bf16 v[64:79], v[168:171], v[152:155], 0
    v_cvt_pk_bf16_f32 v102, v116, v117
    v_cvt_pk_bf16_f32 v103, v118, v119
    v_exp_f32 v112, v80
    v_exp_f32 v113, v81
    v_exp_f32 v114, v82
    v_exp_f32 v115, v83
    v_mfma_f32_32x32x16_bf16 v[64:79], v[172:175], v[156:159], v[64:79]
    v_cvt_pk_bf16_f32 v104, v112, v113
    v_cvt_pk_bf16_f32 v105, v114, v115
    v_exp_f32 v116, v84
    v_exp_f32 v117, v85
    v_exp_f32 v118, v86
    v_exp_f32 v119, v87
    v_mfma_f32_32x32x16_bf16 v[0:15], v[180:183], v[100:103], v[0:15]
    v_cvt_pk_bf16_f32 v106, v116, v117
    v_cvt_pk_bf16_f32 v107, v118, v119
    v_exp_f32 v112, v88
    v_exp_f32 v113, v89
    v_exp_f32 v114, v90
    v_exp_f32 v115, v91
    v_mfma_f32_32x32x16_bf16 v[16:31], v[176:179], v[104:107], v[16:31]
    buffer_load_dwordx4 v[220:223], v244, s[44:47], s31 offen offset:1024 sc1
    v_cvt_pk_bf16_f32 v108, v112, v113
    v_cvt_pk_bf16_f32 v109, v114, v115
    v_exp_f32 v116, v92
    v_exp_f32 v117, v93
    v_exp_f32 v118, v94
    v_exp_f32 v119, v95
    v_mfma_f32_32x32x16_bf16 v[80:95], v[168:171], v[160:163], 0
    v_cvt_pk_bf16_f32 v110, v116, v117
    v_cvt_pk_bf16_f32 v111, v118, v119
    v_exp_f32 v112, v64
    v_exp_f32 v113, v65
    v_exp_f32 v114, v66
    v_exp_f32 v115, v67
    v_mfma_f32_32x32x16_bf16 v[80:95], v[172:175], v[164:167], v[80:95]
    v_cvt_pk_bf16_f32 v96, v112, v113
    v_cvt_pk_bf16_f32 v97, v114, v115
    v_exp_f32 v116, v68
    v_exp_f32 v117, v69
    v_exp_f32 v118, v70
    v_exp_f32 v119, v71
    v_mfma_f32_32x32x16_bf16 v[16:31], v[180:183], v[108:111], v[16:31]
    v_cvt_pk_bf16_f32 v98, v116, v117
    v_cvt_pk_bf16_f32 v99, v118, v119
    v_exp_f32 v112, v72
    v_exp_f32 v113, v73
    v_exp_f32 v114, v74
    v_exp_f32 v115, v75
    v_mfma_f32_32x32x16_bf16 v[32:47], v[176:179], v[96:99], v[32:47]
    buffer_load_dwordx4 v[224:227], v244, s[44:47], s41 offen offset:2048 sc1
    v_cvt_pk_bf16_f32 v100, v112, v113
    v_cvt_pk_bf16_f32 v101, v114, v115
    v_exp_f32 v116, v76
    v_exp_f32 v117, v77
    v_exp_f32 v118, v78
    v_exp_f32 v119, v79
    s_waitcnt vmcnt(8)
    v_mfma_f32_32x32x16_bf16 v[64:79], v[184:187], v[136:139], 0
    v_cvt_pk_bf16_f32 v102, v116, v117
    v_cvt_pk_bf16_f32 v103, v118, v119
    v_exp_f32 v112, v80
    v_exp_f32 v113, v81
    v_exp_f32 v114, v82
    v_exp_f32 v115, v83
    v_mfma_f32_32x32x16_bf16 v[64:79], v[188:191], v[140:143], v[64:79]
    v_cvt_pk_bf16_f32 v104, v112, v113
    v_cvt_pk_bf16_f32 v105, v114, v115
    v_exp_f32 v116, v84
    v_exp_f32 v117, v85
    v_exp_f32 v118, v86
    v_exp_f32 v119, v87
    v_mfma_f32_32x32x16_bf16 v[32:47], v[180:183], v[100:103], v[32:47]
    v_cvt_pk_bf16_f32 v106, v116, v117
    v_cvt_pk_bf16_f32 v107, v118, v119
    v_exp_f32 v112, v88
    v_exp_f32 v113, v89
    v_exp_f32 v114, v90
    v_exp_f32 v115, v91
    v_mfma_f32_32x32x16_bf16 v[48:63], v[176:179], v[104:107], v[48:63]
    buffer_load_dwordx4 v[228:231], v244, s[44:47], s41 offen offset:3072 sc1
    v_cvt_pk_bf16_f32 v108, v112, v113
    v_cvt_pk_bf16_f32 v109, v114, v115
    v_exp_f32 v116, v92
    v_exp_f32 v117, v93
    v_exp_f32 v118, v94
    v_exp_f32 v119, v95
    v_mfma_f32_32x32x16_bf16 v[80:95], v[184:187], v[144:147], 0
    v_cvt_pk_bf16_f32 v110, v116, v117
    v_cvt_pk_bf16_f32 v111, v118, v119
    v_exp_f32 v112, v64
    v_exp_f32 v113, v65
    v_exp_f32 v114, v66
    v_exp_f32 v115, v67
    v_mfma_f32_32x32x16_bf16 v[80:95], v[188:191], v[148:151], v[80:95]
    v_cvt_pk_bf16_f32 v96, v112, v113
    v_cvt_pk_bf16_f32 v97, v114, v115
    v_exp_f32 v116, v68
    v_exp_f32 v117, v69
    v_exp_f32 v118, v70
    v_exp_f32 v119, v71
    v_mfma_f32_32x32x16_bf16 v[48:63], v[180:183], v[108:111], v[48:63]
    v_cvt_pk_bf16_f32 v98, v116, v117
    v_cvt_pk_bf16_f32 v99, v118, v119
    v_exp_f32 v112, v72
    v_exp_f32 v113, v73
    v_exp_f32 v114, v74
    v_exp_f32 v115, v75
    v_mfma_f32_32x32x16_bf16 v[0:15], v[192:195], v[96:99], v[0:15]
    buffer_load_dwordx4 v[168:171], v244, s[44:47], s32 offen offset:0 sc1
    v_cvt_pk_bf16_f32 v100, v112, v113
    v_cvt_pk_bf16_f32 v101, v114, v115
    v_exp_f32 v116, v76
    v_exp_f32 v117, v77
    v_exp_f32 v118, v78
    v_exp_f32 v119, v79
    v_mfma_f32_32x32x16_bf16 v[64:79], v[184:187], v[152:155], 0
    v_cvt_pk_bf16_f32 v102, v116, v117
    v_cvt_pk_bf16_f32 v103, v118, v119
    v_exp_f32 v112, v80
    v_exp_f32 v113, v81
    v_exp_f32 v114, v82
    v_exp_f32 v115, v83
    v_mfma_f32_32x32x16_bf16 v[64:79], v[188:191], v[156:159], v[64:79]
    v_cvt_pk_bf16_f32 v104, v112, v113
    v_cvt_pk_bf16_f32 v105, v114, v115
    v_exp_f32 v116, v84
    v_exp_f32 v117, v85
    v_exp_f32 v118, v86
    v_exp_f32 v119, v87
    v_mfma_f32_32x32x16_bf16 v[0:15], v[196:199], v[100:103], v[0:15]
    v_cvt_pk_bf16_f32 v106, v116, v117
    v_cvt_pk_bf16_f32 v107, v118, v119
    v_exp_f32 v112, v88
    v_exp_f32 v113, v89
    v_exp_f32 v114, v90
    v_exp_f32 v115, v91
    v_mfma_f32_32x32x16_bf16 v[16:31], v[192:195], v[104:107], v[16:31]
    buffer_load_dwordx4 v[172:175], v244, s[44:47], s32 offen offset:1024 sc1
    v_cvt_pk_bf16_f32 v108, v112, v113
    v_cvt_pk_bf16_f32 v109, v114, v115
    v_exp_f32 v116, v92
    v_exp_f32 v117, v93
    v_exp_f32 v118, v94
    v_exp_f32 v119, v95
    v_mfma_f32_32x32x16_bf16 v[80:95], v[184:187], v[160:163], 0
    v_cvt_pk_bf16_f32 v110, v116, v117
    v_cvt_pk_bf16_f32 v111, v118, v119
    v_exp_f32 v112, v64
    v_exp_f32 v113, v65
    v_exp_f32 v114, v66
    v_exp_f32 v115, v67
    v_mfma_f32_32x32x16_bf16 v[80:95], v[188:191], v[164:167], v[80:95]
    v_cvt_pk_bf16_f32 v96, v112, v113
    v_cvt_pk_bf16_f32 v97, v114, v115
    v_exp_f32 v116, v68
    v_exp_f32 v117, v69
    v_exp_f32 v118, v70
    v_exp_f32 v119, v71
    v_mfma_f32_32x32x16_bf16 v[16:31], v[196:199], v[108:111], v[16:31]
    v_cvt_pk_bf16_f32 v98, v116, v117
    v_cvt_pk_bf16_f32 v99, v118, v119
    v_exp_f32 v112, v72
    v_exp_f32 v113, v73
    v_exp_f32 v114, v74
    v_exp_f32 v115, v75
    v_mfma_f32_32x32x16_bf16 v[32:47], v[192:195], v[96:99], v[32:47]
    buffer_load_dwordx4 v[176:179], v244, s[44:47], s42 offen offset:0 sc1
    v_cvt_pk_bf16_f32 v100, v112, v113
    v_cvt_pk_bf16_f32 v101, v114, v115
    v_exp_f32 v116, v76
    v_exp_f32 v117, v77
    v_exp_f32 v118, v78
    v_exp_f32 v119, v79
    s_waitcnt vmcnt(7)
    v_mfma_f32_32x32x16_bf16 v[64:79], v[200:203], v[136:139], 0
    v_cvt_pk_bf16_f32 v102, v116, v117
    v_cvt_pk_bf16_f32 v103, v118, v119
    v_exp_f32 v112, v80
    v_exp_f32 v113, v81
    v_exp_f32 v114, v82
    v_exp_f32 v115, v83
    v_mfma_f32_32x32x16_bf16 v[64:79], v[204:207], v[140:143], v[64:79]
    v_cvt_pk_bf16_f32 v104, v112, v113
    v_cvt_pk_bf16_f32 v105, v114, v115
    v_exp_f32 v116, v84
    v_exp_f32 v117, v85
    v_exp_f32 v118, v86
    v_exp_f32 v119, v87
    v_mfma_f32_32x32x16_bf16 v[32:47], v[196:199], v[100:103], v[32:47]
    v_cvt_pk_bf16_f32 v106, v116, v117
    v_cvt_pk_bf16_f32 v107, v118, v119
    v_exp_f32 v112, v88
    v_exp_f32 v113, v89
    v_exp_f32 v114, v90
    v_exp_f32 v115, v91
    v_mfma_f32_32x32x16_bf16 v[48:63], v[192:195], v[104:107], v[48:63]
    buffer_load_dwordx4 v[180:183], v244, s[44:47], s42 offen offset:1024 sc1
    v_cvt_pk_bf16_f32 v108, v112, v113
    v_cvt_pk_bf16_f32 v109, v114, v115
    v_exp_f32 v116, v92
    v_exp_f32 v117, v93
    v_exp_f32 v118, v94
    v_exp_f32 v119, v95
    v_mfma_f32_32x32x16_bf16 v[80:95], v[200:203], v[144:147], 0
    v_cvt_pk_bf16_f32 v110, v116, v117
    v_cvt_pk_bf16_f32 v111, v118, v119
    v_exp_f32 v112, v64
    v_exp_f32 v113, v65
    v_exp_f32 v114, v66
    v_exp_f32 v115, v67
    v_mfma_f32_32x32x16_bf16 v[80:95], v[204:207], v[148:151], v[80:95]
    v_cvt_pk_bf16_f32 v96, v112, v113
    v_cvt_pk_bf16_f32 v97, v114, v115
    v_exp_f32 v116, v68
    v_exp_f32 v117, v69
    v_exp_f32 v118, v70
    v_exp_f32 v119, v71
    v_mfma_f32_32x32x16_bf16 v[48:63], v[196:199], v[108:111], v[48:63]
    v_cvt_pk_bf16_f32 v98, v116, v117
    v_cvt_pk_bf16_f32 v99, v118, v119
    v_exp_f32 v112, v72
    v_exp_f32 v113, v73
    v_exp_f32 v114, v74
    v_exp_f32 v115, v75
    v_mfma_f32_32x32x16_bf16 v[0:15], v[208:211], v[96:99], v[0:15]
    buffer_load_dwordx4 v[184:187], v244, s[44:47], s33 offen offset:0 sc1
    v_cvt_pk_bf16_f32 v100, v112, v113
    v_cvt_pk_bf16_f32 v101, v114, v115
    v_exp_f32 v116, v76
    v_exp_f32 v117, v77
    v_exp_f32 v118, v78
    v_exp_f32 v119, v79
    v_mfma_f32_32x32x16_bf16 v[64:79], v[200:203], v[152:155], 0
    v_cvt_pk_bf16_f32 v102, v116, v117
    v_cvt_pk_bf16_f32 v103, v118, v119
    v_exp_f32 v112, v80
    v_exp_f32 v113, v81
    v_exp_f32 v114, v82
    v_exp_f32 v115, v83
    v_mfma_f32_32x32x16_bf16 v[64:79], v[204:207], v[156:159], v[64:79]
    v_cvt_pk_bf16_f32 v104, v112, v113
    v_cvt_pk_bf16_f32 v105, v114, v115
    v_exp_f32 v116, v84
    v_exp_f32 v117, v85
    v_exp_f32 v118, v86
    v_exp_f32 v119, v87
    v_mfma_f32_32x32x16_bf16 v[0:15], v[212:215], v[100:103], v[0:15]
    v_cvt_pk_bf16_f32 v106, v116, v117
    v_cvt_pk_bf16_f32 v107, v118, v119
    v_exp_f32 v112, v88
    v_exp_f32 v113, v89
    v_exp_f32 v114, v90
    v_exp_f32 v115, v91
    v_mfma_f32_32x32x16_bf16 v[16:31], v[208:211], v[104:107], v[16:31]
    buffer_load_dwordx4 v[188:191], v244, s[44:47], s33 offen offset:1024 sc1
    v_cvt_pk_bf16_f32 v108, v112, v113
    v_cvt_pk_bf16_f32 v109, v114, v115
    v_exp_f32 v116, v92
    v_exp_f32 v117, v93
    v_exp_f32 v118, v94
    v_exp_f32 v119, v95
    v_mfma_f32_32x32x16_bf16 v[80:95], v[200:203], v[160:163], 0
    v_cvt_pk_bf16_f32 v110, v116, v117
    v_cvt_pk_bf16_f32 v111, v118, v119
    v_exp_f32 v112, v64
    v_exp_f32 v113, v65
    v_exp_f32 v114, v66
    v_exp_f32 v115, v67
    v_mfma_f32_32x32x16_bf16 v[80:95], v[204:207], v[164:167], v[80:95]
    v_cvt_pk_bf16_f32 v96, v112, v113
    v_cvt_pk_bf16_f32 v97, v114, v115
    v_exp_f32 v116, v68
    v_exp_f32 v117, v69
    v_exp_f32 v118, v70
    v_exp_f32 v119, v71
    v_mfma_f32_32x32x16_bf16 v[16:31], v[212:215], v[108:111], v[16:31]
    v_cvt_pk_bf16_f32 v98, v116, v117
    v_cvt_pk_bf16_f32 v99, v118, v119
    v_exp_f32 v112, v72
    v_exp_f32 v113, v73
    v_exp_f32 v114, v74
    v_exp_f32 v115, v75
    v_mfma_f32_32x32x16_bf16 v[32:47], v[208:211], v[96:99], v[32:47]
    buffer_load_dwordx4 v[192:195], v244, s[44:47], s42 offen offset:2048 sc1
    v_cvt_pk_bf16_f32 v100, v112, v113
    v_cvt_pk_bf16_f32 v101, v114, v115
    v_exp_f32 v116, v76
    v_exp_f32 v117, v77
    v_exp_f32 v118, v78
    v_exp_f32 v119, v79
    s_waitcnt vmcnt(7)
    v_mfma_f32_32x32x16_bf16 v[64:79], v[216:219], v[136:139], 0
    v_cvt_pk_bf16_f32 v102, v116, v117
    v_cvt_pk_bf16_f32 v103, v118, v119
    v_exp_f32 v112, v80
    v_exp_f32 v113, v81
    v_exp_f32 v114, v82
    v_exp_f32 v115, v83
    v_mfma_f32_32x32x16_bf16 v[64:79], v[220:223], v[140:143], v[64:79]
    v_cvt_pk_bf16_f32 v104, v112, v113
    v_cvt_pk_bf16_f32 v105, v114, v115
    v_exp_f32 v116, v84
    v_exp_f32 v117, v85
    v_exp_f32 v118, v86
    v_exp_f32 v119, v87
    v_mfma_f32_32x32x16_bf16 v[32:47], v[212:215], v[100:103], v[32:47]
    v_cvt_pk_bf16_f32 v106, v116, v117
    v_cvt_pk_bf16_f32 v107, v118, v119
    v_exp_f32 v112, v88
    v_exp_f32 v113, v89
    v_exp_f32 v114, v90
    v_exp_f32 v115, v91
    v_mfma_f32_32x32x16_bf16 v[48:63], v[208:211], v[104:107], v[48:63]
    buffer_load_dwordx4 v[196:199], v244, s[44:47], s42 offen offset:3072 sc1
    v_cvt_pk_bf16_f32 v108, v112, v113
    v_cvt_pk_bf16_f32 v109, v114, v115
    v_exp_f32 v116, v92
    v_exp_f32 v117, v93
    v_exp_f32 v118, v94
    v_exp_f32 v119, v95
    v_mfma_f32_32x32x16_bf16 v[80:95], v[216:219], v[144:147], 0
    v_cvt_pk_bf16_f32 v110, v116, v117
    v_cvt_pk_bf16_f32 v111, v118, v119
    v_exp_f32 v112, v64
    v_exp_f32 v113, v65
    v_exp_f32 v114, v66
    v_exp_f32 v115, v67
    v_mfma_f32_32x32x16_bf16 v[80:95], v[220:223], v[148:151], v[80:95]
    v_cvt_pk_bf16_f32 v96, v112, v113
    v_cvt_pk_bf16_f32 v97, v114, v115
    v_exp_f32 v116, v68
    v_exp_f32 v117, v69
    v_exp_f32 v118, v70
    v_exp_f32 v119, v71
    v_mfma_f32_32x32x16_bf16 v[48:63], v[212:215], v[108:111], v[48:63]
    v_cvt_pk_bf16_f32 v98, v116, v117
    v_cvt_pk_bf16_f32 v99, v118, v119
    v_exp_f32 v112, v72
    v_exp_f32 v113, v73
    v_exp_f32 v114, v74
    v_exp_f32 v115, v75
    v_mfma_f32_32x32x16_bf16 v[0:15], v[224:227], v[96:99], v[0:15]
    buffer_load_dwordx4 v[200:203], v244, s[44:47], s34 offen offset:0 sc1
    v_cvt_pk_bf16_f32 v100, v112, v113
    v_cvt_pk_bf16_f32 v101, v114, v115
    v_exp_f32 v116, v76
    v_exp_f32 v117, v77
    v_exp_f32 v118, v78
    v_exp_f32 v119, v79
    v_mfma_f32_32x32x16_bf16 v[64:79], v[216:219], v[152:155], 0
    v_cvt_pk_bf16_f32 v102, v116, v117
    v_cvt_pk_bf16_f32 v103, v118, v119
    v_exp_f32 v112, v80
    v_exp_f32 v113, v81
    v_exp_f32 v114, v82
    v_exp_f32 v115, v83
    v_mfma_f32_32x32x16_bf16 v[64:79], v[220:223], v[156:159], v[64:79]
    v_cvt_pk_bf16_f32 v104, v112, v113
    v_cvt_pk_bf16_f32 v105, v114, v115
    v_exp_f32 v116, v84
    v_exp_f32 v117, v85
    v_exp_f32 v118, v86
    v_exp_f32 v119, v87
    v_mfma_f32_32x32x16_bf16 v[0:15], v[228:231], v[100:103], v[0:15]
    v_cvt_pk_bf16_f32 v106, v116, v117
    v_cvt_pk_bf16_f32 v107, v118, v119
    v_exp_f32 v112, v88
    v_exp_f32 v113, v89
    v_exp_f32 v114, v90
    v_exp_f32 v115, v91
    v_mfma_f32_32x32x16_bf16 v[16:31], v[224:227], v[104:107], v[16:31]
    buffer_load_dwordx4 v[204:207], v244, s[44:47], s34 offen offset:1024 sc1
    v_cvt_pk_bf16_f32 v108, v112, v113
    v_cvt_pk_bf16_f32 v109, v114, v115
    v_exp_f32 v116, v92
    v_exp_f32 v117, v93
    v_exp_f32 v118, v94
    v_exp_f32 v119, v95
    v_mfma_f32_32x32x16_bf16 v[80:95], v[216:219], v[160:163], 0
    v_cvt_pk_bf16_f32 v110, v116, v117
    v_cvt_pk_bf16_f32 v111, v118, v119
    v_exp_f32 v112, v64
    v_exp_f32 v113, v65
    v_exp_f32 v114, v66
    v_exp_f32 v115, v67
    v_mfma_f32_32x32x16_bf16 v[80:95], v[220:223], v[164:167], v[80:95]
    v_cvt_pk_bf16_f32 v96, v112, v113
    v_cvt_pk_bf16_f32 v97, v114, v115
    v_exp_f32 v116, v68
    v_exp_f32 v117, v69
    v_exp_f32 v118, v70
    v_exp_f32 v119, v71
    v_mfma_f32_32x32x16_bf16 v[16:31], v[228:231], v[108:111], v[16:31]
    v_cvt_pk_bf16_f32 v98, v116, v117
    v_cvt_pk_bf16_f32 v99, v118, v119
    v_exp_f32 v112, v72
    v_exp_f32 v113, v73
    v_exp_f32 v114, v74
    v_exp_f32 v115, v75
    v_mfma_f32_32x32x16_bf16 v[32:47], v[224:227], v[96:99], v[32:47]
    buffer_load_dwordx4 v[208:211], v244, s[44:47], s43 offen offset:0 sc1
    v_cvt_pk_bf16_f32 v100, v112, v113
    v_cvt_pk_bf16_f32 v101, v114, v115
    v_exp_f32 v116, v76
    v_exp_f32 v117, v77
    v_exp_f32 v118, v78
    v_exp_f32 v119, v79
    s_waitcnt vmcnt(7)
    v_mfma_f32_32x32x16_bf16 v[64:79], v[168:171], v[136:139], 0
    v_cvt_pk_bf16_f32 v102, v116, v117
    v_cvt_pk_bf16_f32 v103, v118, v119
    v_exp_f32 v112, v80
    v_exp_f32 v113, v81
    v_exp_f32 v114, v82
    v_exp_f32 v115, v83
    v_mfma_f32_32x32x16_bf16 v[64:79], v[172:175], v[140:143], v[64:79]
    v_cvt_pk_bf16_f32 v104, v112, v113
    v_cvt_pk_bf16_f32 v105, v114, v115
    v_exp_f32 v116, v84
    v_exp_f32 v117, v85
    v_exp_f32 v118, v86
    v_exp_f32 v119, v87
    v_mfma_f32_32x32x16_bf16 v[32:47], v[228:231], v[100:103], v[32:47]
    v_cvt_pk_bf16_f32 v106, v116, v117
    v_cvt_pk_bf16_f32 v107, v118, v119
    v_exp_f32 v112, v88
    v_exp_f32 v113, v89
    v_exp_f32 v114, v90
    v_exp_f32 v115, v91
    v_mfma_f32_32x32x16_bf16 v[48:63], v[224:227], v[104:107], v[48:63]
    buffer_load_dwordx4 v[212:215], v244, s[44:47], s43 offen offset:1024 sc1
    v_cvt_pk_bf16_f32 v108, v112, v113
    v_cvt_pk_bf16_f32 v109, v114, v115
    v_exp_f32 v116, v92
    v_exp_f32 v117, v93
    v_exp_f32 v118, v94
    v_exp_f32 v119, v95
    v_mfma_f32_32x32x16_bf16 v[80:95], v[168:171], v[144:147], 0
    v_cvt_pk_bf16_f32 v110, v116, v117
    v_cvt_pk_bf16_f32 v111, v118, v119
    v_exp_f32 v112, v64
    v_exp_f32 v113, v65
    v_exp_f32 v114, v66
    v_exp_f32 v115, v67
    v_mfma_f32_32x32x16_bf16 v[80:95], v[172:175], v[148:151], v[80:95]
    buffer_load_dwordx4 v[216:219], v244, s[44:47], s35 offen offset:0 sc1
    v_cvt_pk_bf16_f32 v96, v112, v113
    v_cvt_pk_bf16_f32 v97, v114, v115
    v_exp_f32 v116, v68
    v_exp_f32 v117, v69
    v_exp_f32 v118, v70
    v_exp_f32 v119, v71
    v_mfma_f32_32x32x16_bf16 v[48:63], v[228:231], v[108:111], v[48:63]
    v_cvt_pk_bf16_f32 v98, v116, v117
    v_cvt_pk_bf16_f32 v99, v118, v119
    v_exp_f32 v112, v72
    v_exp_f32 v113, v73
    v_exp_f32 v114, v74
    v_exp_f32 v115, v75
    v_mfma_f32_32x32x16_bf16 v[0:15], v[176:179], v[96:99], v[0:15]
    buffer_load_dwordx4 v[220:223], v244, s[44:47], s35 offen offset:1024 sc1
    v_cvt_pk_bf16_f32 v100, v112, v113
    v_cvt_pk_bf16_f32 v101, v114, v115
    v_exp_f32 v116, v76
    v_exp_f32 v117, v77
    v_exp_f32 v118, v78
    v_exp_f32 v119, v79
    v_mfma_f32_32x32x16_bf16 v[64:79], v[168:171], v[152:155], 0
    v_cvt_pk_bf16_f32 v102, v116, v117
    v_cvt_pk_bf16_f32 v103, v118, v119
    v_exp_f32 v112, v80
    v_exp_f32 v113, v81
    v_exp_f32 v114, v82
    v_exp_f32 v115, v83
    v_mfma_f32_32x32x16_bf16 v[64:79], v[172:175], v[156:159], v[64:79]
    buffer_load_dwordx4 v[224:227], v244, s[44:47], s43 offen offset:2048 sc1
    v_cvt_pk_bf16_f32 v104, v112, v113
    v_cvt_pk_bf16_f32 v105, v114, v115
    v_exp_f32 v116, v84
    v_exp_f32 v117, v85
    v_exp_f32 v118, v86
    v_exp_f32 v119, v87
    v_mfma_f32_32x32x16_bf16 v[0:15], v[180:183], v[100:103], v[0:15]
    v_cvt_pk_bf16_f32 v106, v116, v117
    v_cvt_pk_bf16_f32 v107, v118, v119
    v_exp_f32 v112, v88
    v_exp_f32 v113, v89
    v_exp_f32 v114, v90
    v_exp_f32 v115, v91
    v_mfma_f32_32x32x16_bf16 v[16:31], v[176:179], v[104:107], v[16:31]
    buffer_load_dwordx4 v[228:231], v244, s[44:47], s43 offen offset:3072 sc1
    v_cvt_pk_bf16_f32 v108, v112, v113
    v_cvt_pk_bf16_f32 v109, v114, v115
    v_exp_f32 v116, v92
    v_exp_f32 v117, v93
    v_exp_f32 v118, v94
    v_exp_f32 v119, v95
    s_waitcnt vmcnt(8)
    v_mfma_f32_32x32x16_bf16 v[80:95], v[184:187], v[136:139], 0
    v_cvt_pk_bf16_f32 v110, v116, v117
    v_cvt_pk_bf16_f32 v111, v118, v119
    v_exp_f32 v112, v64
    v_exp_f32 v113, v65
    v_exp_f32 v114, v66
    v_exp_f32 v115, v67
    v_mfma_f32_32x32x16_bf16 v[80:95], v[188:191], v[140:143], v[80:95]
    v_cvt_pk_bf16_f32 v96, v112, v113
    v_cvt_pk_bf16_f32 v97, v114, v115
    v_exp_f32 v116, v68
    v_exp_f32 v117, v69
    v_exp_f32 v118, v70
    v_exp_f32 v119, v71
    v_mfma_f32_32x32x16_bf16 v[16:31], v[180:183], v[108:111], v[16:31]
    v_cvt_pk_bf16_f32 v98, v116, v117
    v_cvt_pk_bf16_f32 v99, v118, v119
    v_exp_f32 v112, v72
    v_exp_f32 v113, v73
    v_exp_f32 v114, v74
    v_exp_f32 v115, v75
    v_mfma_f32_32x32x16_bf16 v[32:47], v[176:179], v[96:99], v[32:47]
    v_cvt_pk_bf16_f32 v100, v112, v113
    v_cvt_pk_bf16_f32 v101, v114, v115
    v_exp_f32 v116, v76
    v_exp_f32 v117, v77
    v_exp_f32 v118, v78
    v_exp_f32 v119, v79
    v_mfma_f32_32x32x16_bf16 v[64:79], v[184:187], v[144:147], 0
    v_cvt_pk_bf16_f32 v102, v116, v117
    v_cvt_pk_bf16_f32 v103, v118, v119
    v_exp_f32 v112, v80
    v_exp_f32 v113, v81
    v_exp_f32 v114, v82
    v_exp_f32 v115, v83
    v_mfma_f32_32x32x16_bf16 v[64:79], v[188:191], v[148:151], v[64:79]
    v_cvt_pk_bf16_f32 v104, v112, v113
    v_cvt_pk_bf16_f32 v105, v114, v115
    v_exp_f32 v116, v84
    v_exp_f32 v117, v85
    v_exp_f32 v118, v86
    v_exp_f32 v119, v87
    v_mfma_f32_32x32x16_bf16 v[32:47], v[180:183], v[100:103], v[32:47]
    v_cvt_pk_bf16_f32 v106, v116, v117
    v_cvt_pk_bf16_f32 v107, v118, v119
    v_exp_f32 v112, v88
    v_exp_f32 v113, v89
    v_exp_f32 v114, v90
    v_exp_f32 v115, v91
    v_mfma_f32_32x32x16_bf16 v[0:15], v[192:195], v[104:107], v[0:15]
    v_cvt_pk_bf16_f32 v108, v112, v113
    v_cvt_pk_bf16_f32 v109, v114, v115
    v_exp_f32 v116, v92
    v_exp_f32 v117, v93
    v_exp_f32 v118, v94
    v_exp_f32 v119, v95
    v_mfma_f32_32x32x16_bf16 v[80:95], v[184:187], v[152:155], 0
    v_cvt_pk_bf16_f32 v110, v116, v117
    v_cvt_pk_bf16_f32 v111, v118, v119
    v_exp_f32 v112, v64
    v_exp_f32 v113, v65
    v_exp_f32 v114, v66
    v_exp_f32 v115, v67
    v_mfma_f32_32x32x16_bf16 v[80:95], v[188:191], v[156:159], v[80:95]
    v_cvt_pk_bf16_f32 v96, v112, v113
    v_cvt_pk_bf16_f32 v97, v114, v115
    v_exp_f32 v116, v68
    v_exp_f32 v117, v69
    v_exp_f32 v118, v70
    v_exp_f32 v119, v71
    v_mfma_f32_32x32x16_bf16 v[0:15], v[196:199], v[108:111], v[0:15]
    v_cvt_pk_bf16_f32 v98, v116, v117
    v_cvt_pk_bf16_f32 v99, v118, v119
    v_exp_f32 v112, v72
    v_exp_f32 v113, v73
    v_exp_f32 v114, v74
    v_exp_f32 v115, v75
    v_mfma_f32_32x32x16_bf16 v[16:31], v[192:195], v[96:99], v[16:31]
    v_cvt_pk_bf16_f32 v100, v112, v113
    v_cvt_pk_bf16_f32 v101, v114, v115
    v_exp_f32 v116, v76
    v_exp_f32 v117, v77
    v_exp_f32 v118, v78
    v_exp_f32 v119, v79
    s_waitcnt vmcnt(4)
    v_mfma_f32_32x32x16_bf16 v[64:79], v[200:203], v[136:139], 0
    v_cvt_pk_bf16_f32 v102, v116, v117
    v_cvt_pk_bf16_f32 v103, v118, v119
    v_exp_f32 v112, v80
    v_exp_f32 v113, v81
    v_exp_f32 v114, v82
    v_exp_f32 v115, v83
    v_mfma_f32_32x32x16_bf16 v[64:79], v[204:207], v[140:143], v[64:79]
    v_cvt_pk_bf16_f32 v104, v112, v113
    v_cvt_pk_bf16_f32 v105, v114, v115
    v_exp_f32 v116, v84
    v_exp_f32 v117, v85
    v_exp_f32 v118, v86
    v_exp_f32 v119, v87
    v_mfma_f32_32x32x16_bf16 v[16:31], v[196:199], v[100:103], v[16:31]
    v_cvt_pk_bf16_f32 v106, v116, v117
    v_cvt_pk_bf16_f32 v107, v118, v119
    v_exp_f32 v112, v88
    v_exp_f32 v113, v89
    v_exp_f32 v114, v90
    v_exp_f32 v115, v91
    v_mfma_f32_32x32x16_bf16 v[32:47], v[192:195], v[104:107], v[32:47]
    v_cvt_pk_bf16_f32 v108, v112, v113
    v_cvt_pk_bf16_f32 v109, v114, v115
    v_exp_f32 v116, v92
    v_exp_f32 v117, v93
    v_exp_f32 v118, v94
    v_exp_f32 v119, v95
    s_waitcnt vmcnt(0)
    v_mfma_f32_32x32x16_bf16 v[80:95], v[216:219], v[136:139], 0
    v_cvt_pk_bf16_f32 v110, v116, v117
    v_cvt_pk_bf16_f32 v111, v118, v119
    v_exp_f32 v112, v64
    v_exp_f32 v113, v65
    v_exp_f32 v114, v66
    v_exp_f32 v115, v67
    v_mfma_f32_32x32x16_bf16 v[80:95], v[220:223], v[140:143], v[80:95]
    v_cvt_pk_bf16_f32 v96, v112, v113
    v_cvt_pk_bf16_f32 v97, v114, v115
    v_exp_f32 v116, v68
    v_exp_f32 v117, v69
    v_exp_f32 v118, v70
    v_exp_f32 v119, v71
    v_mfma_f32_32x32x16_bf16 v[32:47], v[196:199], v[108:111], v[32:47]
    v_cvt_pk_bf16_f32 v98, v116, v117
    v_cvt_pk_bf16_f32 v99, v118, v119
    v_exp_f32 v112, v72
    v_exp_f32 v113, v73
    v_exp_f32 v114, v74
    v_exp_f32 v115, v75
    v_mfma_f32_32x32x16_bf16 v[0:15], v[208:211], v[96:99], v[0:15]
    v_cvt_pk_bf16_f32 v100, v112, v113
    v_cvt_pk_bf16_f32 v101, v114, v115
    v_exp_f32 v116, v76
    v_exp_f32 v117, v77
    v_exp_f32 v118, v78
    v_exp_f32 v119, v79
    v_mfma_f32_32x32x16_bf16 v[64:79], v[200:203], v[144:147], 0
    v_cvt_pk_bf16_f32 v102, v116, v117
    v_cvt_pk_bf16_f32 v103, v118, v119
    v_exp_f32 v112, v80
    v_exp_f32 v113, v81
    v_exp_f32 v114, v82
    v_exp_f32 v115, v83
    v_mfma_f32_32x32x16_bf16 v[64:79], v[204:207], v[148:151], v[64:79]
    v_cvt_pk_bf16_f32 v104, v112, v113
    v_cvt_pk_bf16_f32 v105, v114, v115
    v_exp_f32 v116, v84
    v_exp_f32 v117, v85
    v_exp_f32 v118, v86
    v_exp_f32 v119, v87
    v_mfma_f32_32x32x16_bf16 v[0:15], v[212:215], v[100:103], v[0:15]
    v_cvt_pk_bf16_f32 v106, v116, v117
    v_cvt_pk_bf16_f32 v107, v118, v119
    v_exp_f32 v112, v88
    v_exp_f32 v113, v89
    v_exp_f32 v114, v90
    v_exp_f32 v115, v91
    v_mfma_f32_32x32x16_bf16 v[0:15], v[224:227], v[104:107], v[0:15]
    v_cvt_pk_bf16_f32 v108, v112, v113
    v_cvt_pk_bf16_f32 v109, v114, v115
    v_exp_f32 v116, v92
    v_exp_f32 v117, v93
    v_exp_f32 v118, v94
    v_exp_f32 v119, v95
    v_mfma_f32_32x32x16_bf16 v[80:95], v[216:219], v[144:147], 0
    v_cvt_pk_bf16_f32 v110, v116, v117
    v_cvt_pk_bf16_f32 v111, v118, v119
    v_exp_f32 v112, v64
    v_exp_f32 v113, v65
    v_exp_f32 v114, v66
    v_exp_f32 v115, v67
    v_mfma_f32_32x32x16_bf16 v[80:95], v[220:223], v[148:151], v[80:95]
    v_cvt_pk_bf16_f32 v96, v112, v113
    v_cvt_pk_bf16_f32 v97, v114, v115
    v_exp_f32 v116, v68
    v_exp_f32 v117, v69
    v_exp_f32 v118, v70
    v_exp_f32 v119, v71
    v_mfma_f32_32x32x16_bf16 v[0:15], v[228:231], v[108:111], v[0:15]
    v_cvt_pk_bf16_f32 v98, v116, v117
    v_cvt_pk_bf16_f32 v99, v118, v119
    v_exp_f32 v112, v72
    v_exp_f32 v113, v73
    v_exp_f32 v114, v74
    v_exp_f32 v115, v75
    v_mfma_f32_32x32x16_bf16 v[16:31], v[208:211], v[96:99], v[16:31]
    v_cvt_pk_bf16_f32 v100, v112, v113
    v_cvt_pk_bf16_f32 v101, v114, v115
    v_exp_f32 v116, v76
    v_exp_f32 v117, v77
    v_exp_f32 v118, v78
    v_exp_f32 v119, v79
    v_mfma_f32_32x32x16_bf16 v[64:79], v[200:203], v[152:155], 0
    ds_write_b128 v120, v[0:3] offset:0
    v_cvt_pk_bf16_f32 v102, v116, v117
    v_cvt_pk_bf16_f32 v103, v118, v119
    v_exp_f32 v112, v80
    v_exp_f32 v113, v81
    v_exp_f32 v114, v82
    v_exp_f32 v115, v83
    v_mfma_f32_32x32x16_bf16 v[64:79], v[204:207], v[156:159], v[64:79]
    v_cvt_pk_bf16_f32 v104, v112, v113
    v_cvt_pk_bf16_f32 v105, v114, v115
    v_exp_f32 v116, v84
    v_exp_f32 v117, v85
    v_exp_f32 v118, v86
    v_exp_f32 v119, v87
    v_mfma_f32_32x32x16_bf16 v[16:31], v[212:215], v[100:103], v[16:31]
    ds_write_b128 v120, v[4:7] offset:1024
    v_cvt_pk_bf16_f32 v106, v116, v117
    v_cvt_pk_bf16_f32 v107, v118, v119
    v_exp_f32 v112, v88
    v_exp_f32 v113, v89
    v_exp_f32 v114, v90
    v_exp_f32 v115, v91
    v_mfma_f32_32x32x16_bf16 v[16:31], v[224:227], v[104:107], v[16:31]
    v_cvt_pk_bf16_f32 v108, v112, v113
    v_cvt_pk_bf16_f32 v109, v114, v115
    v_exp_f32 v116, v92
    v_exp_f32 v117, v93
    v_exp_f32 v118, v94
    v_exp_f32 v119, v95
    v_mfma_f32_32x32x16_bf16 v[80:95], v[216:219], v[152:155], 0
    ds_write_b128 v120, v[8:11] offset:2048
    v_cvt_pk_bf16_f32 v110, v116, v117
    v_cvt_pk_bf16_f32 v111, v118, v119
    v_exp_f32 v112, v64
    v_exp_f32 v113, v65
    v_exp_f32 v114, v66
    v_exp_f32 v115, v67
    v_mfma_f32_32x32x16_bf16 v[80:95], v[220:223], v[156:159], v[80:95]
    v_cvt_pk_bf16_f32 v96, v112, v113
    v_cvt_pk_bf16_f32 v97, v114, v115
    v_exp_f32 v116, v68
    v_exp_f32 v117, v69
    v_exp_f32 v118, v70
    v_exp_f32 v119, v71
    v_mfma_f32_32x32x16_bf16 v[16:31], v[228:231], v[108:111], v[16:31]
    ds_write_b128 v120, v[12:15] offset:3072
    v_cvt_pk_bf16_f32 v98, v116, v117
    v_cvt_pk_bf16_f32 v99, v118, v119
    v_exp_f32 v112, v72
    v_exp_f32 v113, v73
    v_exp_f32 v114, v74
    v_exp_f32 v115, v75
    v_mfma_f32_32x32x16_bf16 v[32:47], v[208:211], v[96:99], v[32:47]
    v_cvt_pk_bf16_f32 v100, v112, v113
    v_cvt_pk_bf16_f32 v101, v114, v115
    v_exp_f32 v116, v76
    v_exp_f32 v117, v77
    v_exp_f32 v118, v78
    v_exp_f32 v119, v79
    v_mfma_f32_32x32x16_bf16 v[64:79], v[168:171], v[160:163], 0
    ds_write_b128 v121, v[16:19] offset:0
    v_cvt_pk_bf16_f32 v102, v116, v117
    v_cvt_pk_bf16_f32 v103, v118, v119
    v_exp_f32 v112, v80
    v_exp_f32 v113, v81
    v_exp_f32 v114, v82
    v_exp_f32 v115, v83
    v_mfma_f32_32x32x16_bf16 v[64:79], v[172:175], v[164:167], v[64:79]
    v_cvt_pk_bf16_f32 v104, v112, v113
    v_cvt_pk_bf16_f32 v105, v114, v115
    v_exp_f32 v116, v84
    v_exp_f32 v117, v85
    v_exp_f32 v118, v86
    v_exp_f32 v119, v87
    v_mfma_f32_32x32x16_bf16 v[32:47], v[212:215], v[100:103], v[32:47]
    ds_write_b128 v121, v[20:23] offset:1024
    v_cvt_pk_bf16_f32 v106, v116, v117
    v_cvt_pk_bf16_f32 v107, v118, v119
    v_exp_f32 v112, v88
    v_exp_f32 v113, v89
    v_exp_f32 v114, v90
    v_exp_f32 v115, v91
    v_mfma_f32_32x32x16_bf16 v[32:47], v[224:227], v[104:107], v[32:47]
    v_cvt_pk_bf16_f32 v108, v112, v113
    v_cvt_pk_bf16_f32 v109, v114, v115
    v_exp_f32 v116, v92
    v_exp_f32 v117, v93
    v_exp_f32 v118, v94
    v_exp_f32 v119, v95
    v_mfma_f32_32x32x16_bf16 v[80:95], v[184:187], v[160:163], 0
    ds_write_b128 v121, v[24:27] offset:2048
    v_cvt_pk_bf16_f32 v110, v116, v117
    v_cvt_pk_bf16_f32 v111, v118, v119
    v_exp_f32 v112, v64
    v_exp_f32 v113, v65
    v_exp_f32 v114, v66
    v_exp_f32 v115, v67
    v_mfma_f32_32x32x16_bf16 v[80:95], v[188:191], v[164:167], v[80:95]
    v_cvt_pk_bf16_f32 v96, v112, v113
    v_cvt_pk_bf16_f32 v97, v114, v115
    v_exp_f32 v116, v68
    v_exp_f32 v117, v69
    v_exp_f32 v118, v70
    v_exp_f32 v119, v71
    v_mfma_f32_32x32x16_bf16 v[32:47], v[228:231], v[108:111], v[32:47]
    ds_write_b128 v121, v[28:31] offset:3072
    v_cvt_pk_bf16_f32 v98, v116, v117
    v_cvt_pk_bf16_f32 v99, v118, v119
    v_exp_f32 v112, v72
    v_exp_f32 v113, v73
    v_exp_f32 v114, v74
    v_exp_f32 v115, v75
    v_mfma_f32_32x32x16_bf16 v[48:63], v[176:179], v[96:99], v[48:63]
    v_cvt_pk_bf16_f32 v100, v112, v113
    v_cvt_pk_bf16_f32 v101, v114, v115
    v_exp_f32 v116, v76
    v_exp_f32 v117, v77
    v_exp_f32 v118, v78
    v_exp_f32 v119, v79
    v_mfma_f32_32x32x16_bf16 v[64:79], v[200:203], v[160:163], 0
    ds_write_b128 v122, v[32:35] offset:0
    v_cvt_pk_bf16_f32 v102, v116, v117
    v_cvt_pk_bf16_f32 v103, v118, v119
    v_exp_f32 v112, v80
    v_exp_f32 v113, v81
    v_exp_f32 v114, v82
    v_exp_f32 v115, v83
    v_mfma_f32_32x32x16_bf16 v[64:79], v[204:207], v[164:167], v[64:79]
    v_cvt_pk_bf16_f32 v104, v112, v113
    v_cvt_pk_bf16_f32 v105, v114, v115
    v_exp_f32 v116, v84
    v_exp_f32 v117, v85
    v_exp_f32 v118, v86
    v_exp_f32 v119, v87
    v_mfma_f32_32x32x16_bf16 v[48:63], v[180:183], v[100:103], v[48:63]
    ds_write_b128 v122, v[36:39] offset:1024
    v_cvt_pk_bf16_f32 v106, v116, v117
    v_cvt_pk_bf16_f32 v107, v118, v119
    v_exp_f32 v112, v88
    v_exp_f32 v113, v89
    v_exp_f32 v114, v90
    v_exp_f32 v115, v91
    v_mfma_f32_32x32x16_bf16 v[48:63], v[192:195], v[104:107], v[48:63]
    v_cvt_pk_bf16_f32 v108, v112, v113
    v_cvt_pk_bf16_f32 v109, v114, v115
    v_exp_f32 v116, v92
    v_exp_f32 v117, v93
    v_exp_f32 v118, v94
    v_exp_f32 v119, v95
    v_mfma_f32_32x32x16_bf16 v[80:95], v[216:219], v[160:163], 0
    ds_write_b128 v122, v[40:43] offset:2048
    v_cvt_pk_bf16_f32 v110, v116, v117
    v_cvt_pk_bf16_f32 v111, v118, v119
    v_exp_f32 v112, v64
    v_exp_f32 v113, v65
    v_exp_f32 v114, v66
    v_exp_f32 v115, v67
    v_mfma_f32_32x32x16_bf16 v[80:95], v[220:223], v[164:167], v[80:95]
    v_cvt_pk_bf16_f32 v96, v112, v113
    v_cvt_pk_bf16_f32 v97, v114, v115
    v_exp_f32 v116, v68
    v_exp_f32 v117, v69
    v_exp_f32 v118, v70
    v_exp_f32 v119, v71
    v_mfma_f32_32x32x16_bf16 v[48:63], v[196:199], v[108:111], v[48:63]
    ds_write_b128 v122, v[44:47] offset:3072
    v_cvt_pk_bf16_f32 v98, v116, v117
    v_cvt_pk_bf16_f32 v99, v118, v119
    v_exp_f32 v112, v72
    v_exp_f32 v113, v73
    v_exp_f32 v114, v74
    v_exp_f32 v115, v75
    v_mfma_f32_32x32x16_bf16 v[48:63], v[208:211], v[96:99], v[48:63]
    v_cvt_pk_bf16_f32 v100, v112, v113
    v_cvt_pk_bf16_f32 v101, v114, v115
    v_exp_f32 v116, v76
    v_exp_f32 v117, v77
    v_exp_f32 v118, v78
    v_exp_f32 v119, v79
    v_cvt_pk_bf16_f32 v102, v116, v117
    v_cvt_pk_bf16_f32 v103, v118, v119
    v_exp_f32 v112, v80
    v_exp_f32 v113, v81
    v_exp_f32 v114, v82
    v_exp_f32 v115, v83
    v_cvt_pk_bf16_f32 v104, v112, v113
    v_cvt_pk_bf16_f32 v105, v114, v115
    v_exp_f32 v116, v84
    v_exp_f32 v117, v85
    v_exp_f32 v118, v86
    v_exp_f32 v119, v87
    v_mfma_f32_32x32x16_bf16 v[48:63], v[212:215], v[100:103], v[48:63]
    v_cvt_pk_bf16_f32 v106, v116, v117
    v_cvt_pk_bf16_f32 v107, v118, v119
    v_exp_f32 v112, v88
    v_exp_f32 v113, v89
    v_exp_f32 v114, v90
    v_exp_f32 v115, v91
    v_mfma_f32_32x32x16_bf16 v[48:63], v[224:227], v[104:107], v[48:63]
    ds_read_b128 v[12:15], v123 offset:3072
    ds_read_b128 v[28:31], v123 offset:19456
    ds_read_b128 v[44:47], v123 offset:35840
    v_cvt_pk_bf16_f32 v108, v112, v113
    v_cvt_pk_bf16_f32 v109, v114, v115
    v_exp_f32 v116, v92
    v_exp_f32 v117, v93
    v_exp_f32 v118, v94
    v_exp_f32 v119, v95
    ds_read_b128 v[0:3], v123 offset:0
    ds_read_b128 v[16:19], v123 offset:16384
    ds_read_b128 v[32:35], v123 offset:32768
    v_cvt_pk_bf16_f32 v110, v116, v117
    v_cvt_pk_bf16_f32 v111, v118, v119
    ds_read_b128 v[4:7], v123 offset:1024
    ds_read_b128 v[20:23], v123 offset:17408
    ds_read_b128 v[36:39], v123 offset:33792
    v_mfma_f32_32x32x16_bf16 v[48:63], v[228:231], v[108:111], v[48:63]
    ds_read_b128 v[8:11], v123 offset:2048
    ds_read_b128 v[24:27], v123 offset:18432
    ds_read_b128 v[40:43], v123 offset:34816
    s_waitcnt lgkmcnt(9)
    v_max3_u32 v112, v12, v28, v44
    v_cmp_eq_u32 vcc, -1, v112
    s_nop 2
    s_cbranch_vccz L_xok
    s_mov_b32 s87, 0
L_xr:
    ds_read_b128 v[12:15], v123 offset:3072
    ds_read_b128 v[28:31], v123 offset:19456
    ds_read_b128 v[44:47], v123 offset:35840
    s_waitcnt lgkmcnt(11)
    ds_read_b128 v[0:3], v123 offset:0
    s_waitcnt lgkmcnt(11)
    ds_read_b128 v[16:19], v123 offset:16384
    s_waitcnt lgkmcnt(11)
    ds_read_b128 v[32:35], v123 offset:32768
    s_waitcnt lgkmcnt(11)
    ds_read_b128 v[4:7], v123 offset:1024
    s_waitcnt lgkmcnt(11)
    ds_read_b128 v[20:23], v123 offset:17408
    s_waitcnt lgkmcnt(11)
    ds_read_b128 v[36:39], v123 offset:33792
    s_waitcnt lgkmcnt(11)
    ds_read_b128 v[8:11], v123 offset:2048
    s_waitcnt lgkmcnt(11)
    ds_read_b128 v[24:27], v123 offset:18432
    s_waitcnt lgkmcnt(11)
    ds_read_b128 v[40:43], v123 offset:34816
    s_add_u32 s87, s87, 1
    s_waitcnt lgkmcnt(0)
    v_max3_u32 v112, v12, v28, v44
    v_cmp_eq_u32 vcc, -1, v112
    s_cmp_lt_u32 s87, 200000
    s_cselect_b64 s[84:85], -1, 0
    s_nop 0
    s_and_b64 vcc, vcc, s[84:85]
    s_cbranch_vccnz L_xr
L_xok:
    s_mov_b64 s[86:87], -1
    v_add_f32 v12, v12, v28
    v_add_f32 v13, v13, v29
    v_add_f32 v14, v14, v30
    v_add_f32 v15, v15, v31
    v_add_f32 v12, v12, v44
    v_add_f32 v13, v13, v45
    v_add_f32 v14, v14, v46
    v_add_f32 v15, v15, v47
    s_waitcnt lgkmcnt(7)
    v_add_f32 v0, v0, v16
    v_add_f32 v1, v1, v17
    v_add_f32 v2, v2, v18
    v_add_f32 v3, v3, v19
    s_waitcnt lgkmcnt(6)
    v_add_f32 v0, v0, v32
    v_add_f32 v1, v1, v33
    v_add_f32 v2, v2, v34
    v_add_f32 v3, v3, v35
    s_waitcnt lgkmcnt(4)
    v_add_f32 v4, v4, v20
    v_add_f32 v5, v5, v21
    v_add_f32 v6, v6, v22
    v_add_f32 v7, v7, v23
    s_waitcnt lgkmcnt(3)
    v_add_f32 v4, v4, v36
    v_add_f32 v5, v5, v37
    v_add_f32 v6, v6, v38
    v_add_f32 v7, v7, v39
    s_waitcnt lgkmcnt(1)
    v_add_f32 v8, v8, v24
    v_add_f32 v9, v9, v25
    v_add_f32 v10, v10, v26
    v_add_f32 v11, v11, v27
    s_waitcnt lgkmcnt(0)
    v_add_f32 v8, v8, v40
    v_add_f32 v9, v9, v41
    v_add_f32 v10, v10, v42
    v_add_f32 v11, v11, v43
    v_add_f32 v60, v60, v12
    v_add_f32 v61, v61, v13
    v_add_f32 v62, v62, v14
    v_add_f32 v63, v63, v15
    v_add_f32 v48, v48, v0
    v_add_f32 v49, v49, v1
    v_add_f32 v50, v50, v2
    v_add_f32 v51, v51, v3
    v_add_f32 v52, v52, v4
    v_add_f32 v53, v53, v5
    v_add_f32 v54, v54, v6
    v_add_f32 v55, v55, v7
    v_add_f32 v56, v56, v8
    v_add_f32 v57, v57, v9
    v_add_f32 v58, v58, v10
    v_add_f32 v59, v59, v11
L_fin:
    v_mov_b32 v124, v60
    v_mov_b32 v125, v60
    s_nop 1
    v_permlane32_swap_b32 v124, v125
    v_rcp_f32 v124, v125
    v_cmp_nle_f32 vcc, 0x2b800000, v125
    v_cmp_nle_f32 s[84:85], v125, s82
    v_mul_f32 v112, v124, v48
    v_mul_f32 v113, v124, v49
    v_mul_f32 v114, v124, v50
    v_mul_f32 v115, v124, v51
    v_mul_f32 v116, v124, v52
    v_mul_f32 v117, v124, v53
    v_mul_f32 v118, v124, v54
    v_mul_f32 v119, v124, v55
    s_or_b64 vcc, vcc, s[84:85]
    s_and_b64 vcc, vcc, s[86:87]
    s_cbranch_vccnz L_slow
    v_cvt_pk_bf16_f32 v48, v112, v113
    v_cvt_pk_bf16_f32 v49, v114, v115
    v_cvt_pk_bf16_f32 v50, v116, v117
    v_cvt_pk_bf16_f32 v51, v118, v119
    buffer_store_dwordx4 v[48:51], v244, s[44:47], s70 offen offset:0 sc1
    v_mul_f32 v56, v124, v56
    v_mul_f32 v57, v124, v57
    v_mul_f32 v58, v124, v58
    v_mul_f32 v59, v124, v59
    v_mul_f32 v60, v124, v60
    v_mul_f32 v61, v124, v61
    v_mul_f32 v62, v124, v62
    v_mul_f32 v63, v124, v63
    v_cvt_pk_bf16_f32 v52, v56, v57
    v_cvt_pk_bf16_f32 v53, v58, v59
    v_cvt_pk_bf16_f32 v54, v60, v61
    v_cvt_pk_bf16_f32 v55, v62, v63
    v_cndmask_b32 v54, v54, 0, s[88:89]
    v_cndmask_b32 v55, v55, 0, s[88:89]
    buffer_store_dwordx4 v[52:55], v244, s[44:47], s70 offen offset:1024 sc1
    s_endpgm
L_slow:
    s_mov_b32 s68, s71
    s_mov_b32 s83, 0
    v_mov_b32 v240, 0xff800000
L_slow1:
    buffer_load_dwordx4 v[168:171], v244, s[44:47], s68 offen offset:0 sc1
    buffer_load_dwordx4 v[172:175], v244, s[44:47], s68 offen offset:1024 sc1
    s_waitcnt vmcnt(0)
    v_mfma_f32_32x32x16_bf16 v[64:79], v[168:171], v[160:163], 0
    v_mfma_f32_32x32x16_bf16 v[64:79], v[172:175], v[164:167], v[64:79]
    s_nop 11
    v_max3_f32 v240, v64, v65, v240
    v_max3_f32 v240, v66, v67, v240
    v_max3_f32 v240, v68, v69, v240
    v_max3_f32 v240, v70, v71, v240
    v_max3_f32 v240, v72, v73, v240
    v_max3_f32 v240, v74, v75, v240
    v_max3_f32 v240, v76, v77, v240
    v_max3_f32 v240, v78, v79, v240
    s_add_u32 s68, s68, 57344
    s_add_u32 s83, s83, 1
    s_cmp_lt_u32 s83, 64
    s_cbranch_scc1 L_slow1
    v_mov_b32 v241, v240
    v_mov_b32 v242, v240
    s_nop 1
    v_permlane32_swap_b32 v241, v242
    v_max_f32 v240, v241, v242
    s_mov_b32 s68, s71
    s_lshl_b32 s69, s66, 17
    s_add_u32 s69, s69, 4718592
    s_mov_b32 s83, 0
    v_mov_b32 v48, 0
    v_mov_b32 v49, 0
    v_mov_b32 v50, 0
    v_mov_b32 v51, 0
    v_mov_b32 v52, 0
    v_mov_b32 v53, 0
    v_mov_b32 v54, 0
    v_mov_b32 v55, 0
    v_mov_b32 v56, 0
    v_mov_b32 v57, 0
    v_mov_b32 v58, 0
    v_mov_b32 v59, 0
    v_mov_b32 v60, 0
    v_mov_b32 v61, 0
    v_mov_b32 v62, 0
    v_mov_b32 v63, 0
L_slow2:
    buffer_load_dwordx4 v[168:171], v244, s[44:47], s68 offen offset:0 sc1
    buffer_load_dwordx4 v[172:175], v244, s[44:47], s68 offen offset:1024 sc1
    buffer_load_dwordx4 v[176:179], v244, s[44:47], s69 offen offset:0 sc1
    buffer_load_dwordx4 v[180:183], v244, s[44:47], s69 offen offset:1024 sc1
    s_waitcnt vmcnt(0)
    v_mfma_f32_32x32x16_bf16 v[64:79], v[168:171], v[160:163], 0
    v_mfma_f32_32x32x16_bf16 v[64:79], v[172:175], v[164:167], v[64:79]
    s_nop 11
    v_sub_f32 v64, v64, v240
    v_sub_f32 v65, v65, v240
    v_sub_f32 v66, v66, v240
    v_sub_f32 v67, v67, v240
    v_sub_f32 v68, v68, v240
    v_sub_f32 v69, v69, v240
    v_sub_f32 v70, v70, v240
    v_sub_f32 v71, v71, v240
    v_sub_f32 v72, v72, v240
    v_sub_f32 v73, v73, v240
    v_sub_f32 v74, v74, v240
    v_sub_f32 v75, v75, v240
    v_sub_f32 v76, v76, v240
    v_sub_f32 v77, v77, v240
    v_sub_f32 v78, v78, v240
    v_sub_f32 v79, v79, v240
    v_exp_f32 v64, v64
    v_exp_f32 v65, v65
    v_exp_f32 v66, v66
    v_exp_f32 v67, v67
    v_exp_f32 v68, v68
    v_exp_f32 v69, v69
    v_exp_f32 v70, v70
    v_exp_f32 v71, v71
    v_exp_f32 v72, v72
    v_exp_f32 v73, v73
    v_exp_f32 v74, v74
    v_exp_f32 v75, v75
    v_exp_f32 v76, v76
    v_exp_f32 v77, v77
    v_exp_f32 v78, v78
    v_exp_f32 v79, v79
    v_cvt_pk_bf16_f32 v96, v64, v65
    v_cvt_pk_bf16_f32 v97, v66, v67
    v_cvt_pk_bf16_f32 v98, v68, v69
    v_cvt_pk_bf16_f32 v99, v70, v71
    v_cvt_pk_bf16_f32 v100, v72, v73
    v_cvt_pk_bf16_f32 v101, v74, v75
    v_cvt_pk_bf16_f32 v102, v76, v77
    v_cvt_pk_bf16_f32 v103, v78, v79
    v_mfma_f32_32x32x16_bf16 v[48:63], v[176:179], v[96:99], v[48:63]
    s_nop 0
    v_mfma_f32_32x32x16_bf16 v[48:63], v[180:183], v[100:103], v[48:63]
    s_add_u32 s68, s68, 57344
    s_add_u32 s69, s69, 2048
    s_add_u32 s83, s83, 1
    s_cmp_lt_u32 s83, 64
    s_nop 7
    s_cbranch_scc1 L_slow2
    s_nop 15
    s_mov_b64 s[86:87], 0
    s_branch L_fin
L_passA1:
    s_setprio 1
    s_add_u32 m0, s73, 106496
    s_waitcnt lgkmcnt(2)
    v_mfma_f32_32x32x16_bf16 v[48:63], v[80:83], v[128:131], 0
    ds_read_b64_tr_b16 v[92:93], v105 offset:49152
    ds_read_b64_tr_b16 v[94:95], v105 offset:49664
    buffer_load_dwordx4 v242, s[36:39], s71 offen lds
    v_mfma_f32_16x16x32_bf16 v[116:119], v[112:115], v[80:83], 0
    s_add_u32 m0, s73, 114688
    s_waitcnt lgkmcnt(2)
    v_mfma_f32_32x32x16_bf16 v[64:79], v[84:87], v[128:131], 0
    ds_read_b64_tr_b16 v[96:97], v109 offset:49152
    ds_read_b64_tr_b16 v[98:99], v109 offset:49664
    buffer_load_dwordx4 v243, s[40:43], s71 offen lds
    s_waitcnt lgkmcnt(2)
    v_mfma_f32_32x32x16_bf16 v[48:63], v[92:95], v[132:135], v[48:63]
    ds_read_b64_tr_b16 v[80:81], v106 offset:49152
    ds_read_b64_tr_b16 v[82:83], v106 offset:49664
    s_waitcnt lgkmcnt(2)
    v_mfma_f32_32x32x16_bf16 v[64:79], v[96:99], v[132:135], v[64:79]
    ds_read_b64_tr_b16 v[84:85], v110 offset:49152
    ds_read_b64_tr_b16 v[86:87], v110 offset:49664
    v_mfma_f32_16x16x32_bf16 v[120:123], v[112:115], v[96:99], 0
    s_waitcnt lgkmcnt(2)
    v_mfma_f32_32x32x16_bf16 v[48:63], v[80:83], v[136:139], v[48:63]
    ds_read_b64_tr_b16 v[92:93], v107 offset:49152
    ds_read_b64_tr_b16 v[94:95], v107 offset:49664
    ds_read_b64_tr_b16 v[96:97], v111 offset:49152
    ds_read_b64_tr_b16 v[98:99], v111 offset:49664
    s_waitcnt lgkmcnt(4)
    v_mfma_f32_32x32x16_bf16 v[64:79], v[84:87], v[136:139], v[64:79]
    ds_read_b64_tr_b16 v[128:129], v104 offset:0
    ds_read_b64_tr_b16 v[130:131], v104 offset:512
    ds_read_b64_tr_b16 v[132:133], v108 offset:0
    ds_read_b64_tr_b16 v[134:135], v108 offset:512
    v_add_u32 v104, 65536, v104
    v_add_u32 v108, 65536, v108
    s_waitcnt lgkmcnt(6)
    v_mfma_f32_32x32x16_bf16 v[48:63], v[92:95], v[140:143], v[48:63]
    ds_read_b64_tr_b16 v[80:81], v105 offset:0
    ds_read_b64_tr_b16 v[82:83], v105 offset:512
    s_waitcnt lgkmcnt(6)
    v_mfma_f32_32x32x16_bf16 v[64:79], v[96:99], v[140:143], v[64:79]
    ds_read_b64_tr_b16 v[84:85], v109 offset:0
    ds_read_b64_tr_b16 v[86:87], v109 offset:512
    v_add_u32 v105, 65536, v105
    v_add_u32 v109, 65536, v109
    s_waitcnt lgkmcnt(6)
    v_mfma_f32_32x32x16_bf16 v[48:63], v[128:131], v[144:147], v[48:63]
    ds_read_b64_tr_b16 v[92:93], v106 offset:0
    ds_read_b64_tr_b16 v[94:95], v106 offset:512
    v_mfma_f32_16x16x32_bf16 v[116:119], v[112:115], v[128:131], v[116:119]
    s_waitcnt lgkmcnt(6)
    v_mfma_f32_32x32x16_bf16 v[64:79], v[132:135], v[144:147], v[64:79]
    ds_read_b64_tr_b16 v[96:97], v110 offset:0
    ds_read_b64_tr_b16 v[98:99], v110 offset:512
    v_add_u32 v106, 65536, v106
    v_add_u32 v110, 65536, v110
    s_setprio 0
    s_cmp_eq_u32 s78, 2
    s_cbranch_scc1 L_epiVh
    s_cmp_eq_u32 s78, 3
    s_cbranch_scc1 L_epiGh
    v_mul_f32 v0, v247, v0
    v_mul_f32 v1, v247, v1
    v_mul_f32 v2, v247, v2
    v_mul_f32 v3, v247, v3
    v_mul_f32 v4, v247, v4
    v_mul_f32 v5, v247, v5
    v_mul_f32 v6, v247, v6
    v_mul_f32 v7, v247, v7
    v_cvt_pk_bf16_f32 v0, v0, v1
    v_cvt_pk_bf16_f32 v1, v2, v3
    v_cvt_pk_bf16_f32 v2, v4, v5
    v_cvt_pk_bf16_f32 v3, v6, v7
    buffer_store_dwordx4 v[0:3], v244, s[44:47], s4 offen offset:0 sc1
    v_mul_f32 v8, v247, v8
    v_mul_f32 v9, v247, v9
    v_mul_f32 v10, v247, v10
    v_mul_f32 v11, v247, v11
    v_mul_f32 v12, v247, v12
    v_mul_f32 v13, v247, v13
    v_mul_f32 v14, v247, v14
    v_mul_f32 v15, v247, v15
    v_cvt_pk_bf16_f32 v4, v8, v9
    v_cvt_pk_bf16_f32 v5, v10, v11
    v_cvt_pk_bf16_f32 v6, v12, v13
    v_cvt_pk_bf16_f32 v7, v14, v15
    buffer_store_dwordx4 v[4:7], v244, s[44:47], s4 offen offset:1024 sc1
    s_cmp_eq_u32 s78, 0
    s_cbranch_scc0 L_epiGh
    v_mul_f32 v16, v247, v16
    v_mul_f32 v17, v247, v17
    v_mul_f32 v18, v247, v18
    v_mul_f32 v19, v247, v19
    v_mul_f32 v20, v247, v20
    v_mul_f32 v21, v247, v21
    v_mul_f32 v22, v247, v22
    v_mul_f32 v23, v247, v23
    v_cvt_pk_bf16_f32 v16, v16, v17
    v_cvt_pk_bf16_f32 v17, v18, v19
    v_cvt_pk_bf16_f32 v18, v20, v21
    v_cvt_pk_bf16_f32 v19, v22, v23
    buffer_store_dwordx4 v[16:19], v244, s[44:47], s5 offen offset:0 sc1
    v_mul_f32 v24, v247, v24
    v_mul_f32 v25, v247, v25
    v_mul_f32 v26, v247, v26
    v_mul_f32 v27, v247, v27
    v_mul_f32 v28, v247, v28
    v_mul_f32 v29, v247, v29
    v_mul_f32 v30, v247, v30
    v_mul_f32 v31, v247, v31
    v_cvt_pk_bf16_f32 v20, v24, v25
    v_cvt_pk_bf16_f32 v21, v26, v27
    v_cvt_pk_bf16_f32 v22, v28, v29
    v_cvt_pk_bf16_f32 v23, v30, v31
    buffer_store_dwordx4 v[20:23], v244, s[44:47], s5 offen offset:1024 sc1
    v_mul_f32 v32, v247, v32
    v_mul_f32 v33, v247, v33
    v_mul_f32 v34, v247, v34
    v_mul_f32 v35, v247, v35
    v_mul_f32 v36, v247, v36
    v_mul_f32 v37, v247, v37
    v_mul_f32 v38, v247, v38
    v_mul_f32 v39, v247, v39
    v_cvt_pk_bf16_f32 v32, v32, v33
    v_cvt_pk_bf16_f32 v33, v34, v35
    v_cvt_pk_bf16_f32 v34, v36, v37
    v_cvt_pk_bf16_f32 v35, v38, v39
    buffer_store_dwordx4 v[32:35], v244, s[44:47], s6 offen offset:0 sc1
    v_mul_f32 v40, v247, v40
    v_mul_f32 v41, v247, v41
    v_mul_f32 v42, v247, v42
    v_mul_f32 v43, v247, v43
    v_mul_f32 v44, v247, v44
    v_mul_f32 v45, v247, v45
    v_mul_f32 v46, v247, v46
    v_mul_f32 v47, v247, v47
    v_cvt_pk_bf16_f32 v36, v40, v41
    v_cvt_pk_bf16_f32 v37, v42, v43
    v_cvt_pk_bf16_f32 v38, v44, v45
    v_cvt_pk_bf16_f32 v39, v46, v47
    buffer_store_dwordx4 v[36:39], v244, s[44:47], s6 offen offset:1024 sc1
    s_branch L_epiEh
L_epiVh:
    v_mul_f32 v0, v247, v0
    v_mul_f32 v1, v247, v1
    v_mul_f32 v2, v247, v2
    v_mul_f32 v3, v247, v3
    v_mul_f32 v4, v247, v4
    v_mul_f32 v5, v247, v5
    v_mul_f32 v6, v247, v6
    v_mul_f32 v7, v247, v7
    v_cvt_pk_bf16_f32 v0, v0, v1
    v_cvt_pk_bf16_f32 v1, v2, v3
    v_cvt_pk_bf16_f32 v2, v4, v5
    v_cvt_pk_bf16_f32 v3, v6, v7
    ds_write_b128 v88, v[0:3] offset:32768
    v_mul_f32 v8, v247, v8
    v_mul_f32 v9, v247, v9
    v_mul_f32 v10, v247, v10
    v_mul_f32 v11, v247, v11
    v_mul_f32 v12, v247, v12
    v_mul_f32 v13, v247, v13
    v_mul_f32 v14, v247, v14
    v_mul_f32 v15, v247, v15
    v_cvt_pk_bf16_f32 v4, v8, v9
    v_cvt_pk_bf16_f32 v5, v10, v11
    v_cvt_pk_bf16_f32 v6, v12, v13
    v_cvt_pk_bf16_f32 v7, v14, v15
    ds_write_b128 v89, v[4:7] offset:32768
    ds_read_b64_tr_b16 v[8:9], v90 offset:32768
    ds_read_b64_tr_b16 v[10:11], v90 offset:33280
    ds_read_b64_tr_b16 v[12:13], v90 offset:33792
    ds_read_b64_tr_b16 v[14:15], v90 offset:34304
    v_max_f32 v16, 0, v16
    v_mul_f32 v24, v240, v24
    v_mul_f32 v16, v16, v24
    v_max_f32 v17, 0, v17
    v_mul_f32 v25, v240, v25
    v_mul_f32 v17, v17, v25
    v_max_f32 v18, 0, v18
    v_mul_f32 v26, v240, v26
    v_mul_f32 v18, v18, v26
    v_max_f32 v19, 0, v19
    v_mul_f32 v27, v240, v27
    v_mul_f32 v19, v19, v27
    v_max_f32 v20, 0, v20
    v_mul_f32 v28, v240, v28
    v_mul_f32 v20, v20, v28
    v_max_f32 v21, 0, v21
    v_mul_f32 v29, v240, v29
    v_mul_f32 v21, v21, v29
    v_max_f32 v22, 0, v22
    v_mul_f32 v30, v240, v30
    s_waitcnt lgkmcnt(0)
    buffer_store_dwordx4 v[8:11], v91, s[44:47], s4 offen offset:0 sc1
    buffer_store_dwordx4 v[12:15], v91, s[44:47], s4 offen offset:1024 sc1
    v_mul_f32 v22, v22, v30
    v_max_f32 v23, 0, v23
    v_mul_f32 v31, v240, v31
    v_mul_f32 v23, v23, v31
    v_cvt_pk_bf16_f32 v16, v16, v17
    v_cvt_pk_bf16_f32 v17, v18, v19
    v_cvt_pk_bf16_f32 v18, v20, v21
    v_cvt_pk_bf16_f32 v19, v22, v23
    v_max_f32 v32, 0, v32
    v_mul_f32 v40, v240, v40
    v_mul_f32 v32, v32, v40
    v_max_f32 v33, 0, v33
    v_mul_f32 v41, v240, v41
    v_mul_f32 v33, v33, v41
    v_max_f32 v34, 0, v34
    v_mul_f32 v42, v240, v42
    v_mul_f32 v34, v34, v42
    v_max_f32 v35, 0, v35
    v_mul_f32 v43, v240, v43
    v_mul_f32 v35, v35, v43
    v_max_f32 v36, 0, v36
    v_mul_f32 v44, v240, v44
    v_mul_f32 v36, v36, v44
    v_max_f32 v37, 0, v37
    v_mul_f32 v45, v240, v45
    v_mul_f32 v37, v37, v45
    v_max_f32 v38, 0, v38
    v_mul_f32 v46, v240, v46
    v_mul_f32 v38, v38, v46
    v_max_f32 v39, 0, v39
    v_mul_f32 v47, v240, v47
    v_mul_f32 v39, v39, v47
    v_cvt_pk_bf16_f32 v32, v32, v33
    v_cvt_pk_bf16_f32 v33, v34, v35
    v_cvt_pk_bf16_f32 v34, v36, v37
    v_cvt_pk_bf16_f32 v35, v38, v39
    s_branch L_epiEh
L_epiGh:
    v_max_f32 v16, 0, v16
    v_mul_f32 v24, v240, v24
    v_mul_f32 v16, v16, v24
    v_max_f32 v17, 0, v17
    v_mul_f32 v25, v240, v25
    v_mul_f32 v17, v17, v25
    v_max_f32 v18, 0, v18
    v_mul_f32 v26, v240, v26
    v_mul_f32 v18, v18, v26
    v_max_f32 v19, 0, v19
    v_mul_f32 v27, v240, v27
    v_mul_f32 v19, v19, v27
    v_max_f32 v20, 0, v20
    v_mul_f32 v28, v240, v28
    v_mul_f32 v20, v20, v28
    v_max_f32 v21, 0, v21
    v_mul_f32 v29, v240, v29
    v_mul_f32 v21, v21, v29
    v_max_f32 v22, 0, v22
    v_mul_f32 v30, v240, v30
    v_mul_f32 v22, v22, v30
    v_max_f32 v23, 0, v23
    v_mul_f32 v31, v240, v31
    v_mul_f32 v23, v23, v31
    v_cvt_pk_bf16_f32 v16, v16, v17
    v_cvt_pk_bf16_f32 v17, v18, v19
    v_cvt_pk_bf16_f32 v18, v20, v21
    v_cvt_pk_bf16_f32 v19, v22, v23
    v_max_f32 v32, 0, v32
    v_mul_f32 v40, v240, v40
    v_mul_f32 v32, v32, v40
    v_max_f32 v33, 0, v33
    v_mul_f32 v41, v240, v41
    v_mul_f32 v33, v33, v41
    v_max_f32 v34, 0, v34
    v_mul_f32 v42, v240, v42
    v_mul_f32 v34, v34, v42
    v_max_f32 v35, 0, v35
    v_mul_f32 v43, v240, v43
    v_mul_f32 v35, v35, v43
    v_max_f32 v36, 0, v36
    v_mul_f32 v44, v240, v44
    v_mul_f32 v36, v36, v44
    v_max_f32 v37, 0, v37
    v_mul_f32 v45, v240, v45
    v_mul_f32 v37, v37, v45
    v_max_f32 v38, 0, v38
    v_mul_f32 v46, v240, v46
    v_mul_f32 v38, v38, v46
    v_max_f32 v39, 0, v39
    v_mul_f32 v47, v240, v47
    v_mul_f32 v39, v39, v47
    v_cvt_pk_bf16_f32 v32, v32, v33
    v_cvt_pk_bf16_f32 v33, v34, v35
    v_cvt_pk_bf16_f32 v34, v36, v37
    v_cvt_pk_bf16_f32 v35, v38, v39
L_epiEh:
    s_setprio 1
    s_waitcnt lgkmcnt(6)
    v_mfma_f32_32x32x16_bf16 v[48:63], v[80:83], v[148:151], v[48:63]
    ds_read_b64_tr_b16 v[128:129], v107 offset:0
    ds_read_b64_tr_b16 v[130:131], v107 offset:512
    s_waitcnt lgkmcnt(6)
    v_mfma_f32_32x32x16_bf16 v[64:79], v[84:87], v[148:151], v[64:79]
    ds_read_b64_tr_b16 v[132:133], v111 offset:0
    ds_read_b64_tr_b16 v[134:135], v111 offset:512
    v_add_u32 v107, 65536, v107
    v_add_u32 v111, 65536, v111
    v_mfma_f32_16x16x32_bf16 v[120:123], v[112:115], v[84:87], v[120:123]
    s_waitcnt lgkmcnt(6)
    v_mfma_f32_32x32x16_bf16 v[48:63], v[92:95], v[152:155], v[48:63]
    ds_read_b64_tr_b16 v[80:81], v104 offset:24576
    ds_read_b64_tr_b16 v[82:83], v104 offset:25088
    s_waitcnt lgkmcnt(6)
    v_mfma_f32_32x32x16_bf16 v[64:79], v[96:99], v[152:155], v[64:79]
    ds_read_b64_tr_b16 v[84:85], v108 offset:24576
    ds_read_b64_tr_b16 v[86:87], v108 offset:25088
    s_waitcnt lgkmcnt(6)
    v_mfma_f32_32x32x16_bf16 v[48:63], v[128:131], v[156:159], v[48:63]
    ds_read_b64_tr_b16 v[92:93], v105 offset:24576
    ds_read_b64_tr_b16 v[94:95], v105 offset:25088
    s_waitcnt lgkmcnt(6)
    v_mfma_f32_32x32x16_bf16 v[64:79], v[132:135], v[156:159], v[64:79]
    ds_read_b64_tr_b16 v[96:97], v109 offset:24576
    ds_read_b64_tr_b16 v[98:99], v109 offset:25088
    s_waitcnt lgkmcnt(6)
    v_mfma_f32_32x32x16_bf16 v[48:63], v[80:83], v[160:163], v[48:63]
    ds_read_b64_tr_b16 v[128:129], v106 offset:24576
    ds_read_b64_tr_b16 v[130:131], v106 offset:25088
    v_mfma_f32_16x16x32_bf16 v[116:119], v[112:115], v[80:83], v[116:119]
    s_waitcnt lgkmcnt(6)
    v_mfma_f32_32x32x16_bf16 v[64:79], v[84:87], v[160:163], v[64:79]
    ds_read_b64_tr_b16 v[132:133], v110 offset:24576
    ds_read_b64_tr_b16 v[134:135], v110 offset:25088
    s_waitcnt lgkmcnt(6)
    v_mfma_f32_32x32x16_bf16 v[48:63], v[92:95], v[164:167], v[48:63]
    ds_read_b64_tr_b16 v[80:81], v107 offset:24576
    ds_read_b64_tr_b16 v[82:83], v107 offset:25088
    s_waitcnt vmcnt(0)
    s_barrier
    s_cmp_eq_u32 s60, 4
    s_cbranch_scc0 L_f1
    s_mov_b64 exec, 1
    buffer_store_dword v246, v244, s[44:47], s9 offen sc1
    s_mov_b64 exec, -1
L_f1:
    s_waitcnt lgkmcnt(6)
    v_mfma_f32_32x32x16_bf16 v[64:79], v[96:99], v[164:167], v[64:79]
    ds_read_b64_tr_b16 v[84:85], v111 offset:24576
    ds_read_b64_tr_b16 v[86:87], v111 offset:25088
    s_lshl2_add_u32 s82, s2, s79
    s_mul_i32 s82, s82, 49
    s_lshr_b32 s83, s82, 2
    s_lshr_b32 s82, s82, 4
    v_min_u32 v88, 12, v245
    v_min_u32 v89, 3, v245
    v_add_lshl_u32 v88, v88, s83, 7
    v_add_lshl_u32 v89, v89, s82, 7
    buffer_load_dword v90, v88, s[48:51], 0 offen
    buffer_load_dword v91, v89, s[52:55], 0 offen
    v_mfma_f32_16x16x32_bf16 v[120:123], v[112:115], v[96:99], v[120:123]
    s_waitcnt lgkmcnt(6)
    v_mfma_f32_32x32x16_bf16 v[48:63], v[128:131], v[168:171], v[48:63]
    ds_read_b64_tr_b16 v[92:93], v104 offset:57344
    ds_read_b64_tr_b16 v[94:95], v104 offset:57856
    s_cmp_eq_u32 s78, 0
    s_cbranch_scc1 L_gush
    buffer_store_dwordx4 v[16:19], v244, s[44:47], s7 offen offset:0 sc1
    buffer_store_dwordx4 v[32:35], v244, s[44:47], s7 offen offset:1024 sc1
L_gush:
    s_waitcnt lgkmcnt(6)
    v_mfma_f32_32x32x16_bf16 v[64:79], v[132:135], v[168:171], v[64:79]
    ds_read_b64_tr_b16 v[96:97], v108 offset:57344
    ds_read_b64_tr_b16 v[98:99], v108 offset:57856
    v_subrev_u32 v104, 65536, v104
    v_subrev_u32 v108, 65536, v108
    s_waitcnt lgkmcnt(6)
    v_mfma_f32_32x32x16_bf16 v[48:63], v[80:83], v[172:175], v[48:63]
    ds_read_b64_tr_b16 v[128:129], v105 offset:57344
    ds_read_b64_tr_b16 v[130:131], v105 offset:57856
    s_waitcnt lgkmcnt(6)
    v_mfma_f32_32x32x16_bf16 v[64:79], v[84:87], v[172:175], v[64:79]
    ds_read_b64_tr_b16 v[132:133], v109 offset:57344
    ds_read_b64_tr_b16 v[134:135], v109 offset:57856
    v_subrev_u32 v105, 65536, v105
    v_subrev_u32 v109, 65536, v109
    s_waitcnt lgkmcnt(6)
    v_mfma_f32_32x32x16_bf16 v[48:63], v[92:95], v[176:179], v[48:63]
    ds_read_b64_tr_b16 v[80:81], v106 offset:57344
    ds_read_b64_tr_b16 v[82:83], v106 offset:57856
    v_mfma_f32_16x16x32_bf16 v[116:119], v[112:115], v[92:95], v[116:119]
    s_waitcnt lgkmcnt(6)
    v_mfma_f32_32x32x16_bf16 v[64:79], v[96:99], v[176:179], v[64:79]
    ds_read_b64_tr_b16 v[84:85], v110 offset:57344
    ds_read_b64_tr_b16 v[86:87], v110 offset:57856
    v_subrev_u32 v106, 65536, v106
    v_subrev_u32 v110, 65536, v110
    s_waitcnt lgkmcnt(6)
    v_mfma_f32_32x32x16_bf16 v[48:63], v[128:131], v[180:183], v[48:63]
    ds_read_b64_tr_b16 v[92:93], v107 offset:57344
    ds_read_b64_tr_b16 v[94:95], v107 offset:57856
    s_waitcnt lgkmcnt(6)
    v_mfma_f32_32x32x16_bf16 v[64:79], v[132:135], v[180:183], v[64:79]
    ds_read_b64_tr_b16 v[96:97], v111 offset:57344
    ds_read_b64_tr_b16 v[98:99], v111 offset:57856
    v_subrev_u32 v107, 65536, v107
    v_subrev_u32 v111, 65536, v111
    v_mfma_f32_16x16x32_bf16 v[120:123], v[112:115], v[132:135], v[120:123]
    s_waitcnt lgkmcnt(6)
    v_mfma_f32_32x32x16_bf16 v[48:63], v[80:83], v[184:187], v[48:63]
    ds_read_b64_tr_b16 v[128:129], v104 offset:16384
    ds_read_b64_tr_b16 v[130:131], v104 offset:16896
    s_waitcnt lgkmcnt(6)
    v_mfma_f32_32x32x16_bf16 v[64:79], v[84:87], v[184:187], v[64:79]
    ds_read_b64_tr_b16 v[132:133], v108 offset:16384
    ds_read_b64_tr_b16 v[134:135], v108 offset:16896
    v_add_u32 v104, 65536, v104
    v_add_u32 v108, 65536, v108
    s_waitcnt lgkmcnt(6)
    v_mfma_f32_32x32x16_bf16 v[48:63], v[92:95], v[188:191], v[48:63]
    ds_read_b64_tr_b16 v[80:81], v105 offset:16384
    ds_read_b64_tr_b16 v[82:83], v105 offset:16896
    s_waitcnt lgkmcnt(6)
    v_mfma_f32_32x32x16_bf16 v[64:79], v[96:99], v[188:191], v[64:79]
    ds_read_b64_tr_b16 v[84:85], v109 offset:16384
    ds_read_b64_tr_b16 v[86:87], v109 offset:16896
    v_add_u32 v105, 65536, v105
    v_add_u32 v109, 65536, v109
    s_waitcnt lgkmcnt(6)
    v_mfma_f32_32x32x16_bf16 v[48:63], v[128:131], v[192:195], v[48:63]
    ds_read_b64_tr_b16 v[92:93], v106 offset:16384
    ds_read_b64_tr_b16 v[94:95], v106 offset:16896
    v_mfma_f32_16x16x32_bf16 v[116:119], v[112:115], v[128:131], v[116:119]
    s_waitcnt lgkmcnt(6)
    v_mfma_f32_32x32x16_bf16 v[64:79], v[132:135], v[192:195], v[64:79]
    ds_read_b64_tr_b16 v[96:97], v110 offset:16384
    ds_read_b64_tr_b16 v[98:99], v110 offset:16896
    v_add_u32 v106, 65536, v106
    v_add_u32 v110, 65536, v110
    s_waitcnt lgkmcnt(6)
    v_mfma_f32_32x32x16_bf16 v[48:63], v[80:83], v[196:199], v[48:63]
    ds_read_b64_tr_b16 v[128:129], v107 offset:16384
    ds_read_b64_tr_b16 v[130:131], v107 offset:16896
    s_waitcnt lgkmcnt(6)
    v_mfma_f32_32x32x16_bf16 v[64:79], v[84:87], v[196:199], v[64:79]
    ds_read_b64_tr_b16 v[132:133], v111 offset:16384
    ds_read_b64_tr_b16 v[134:135], v111 offset:16896
    v_add_u32 v107, 65536, v107
    v_add_u32 v111, 65536, v111
    v_mfma_f32_16x16x32_bf16 v[120:123], v[112:115], v[84:87], v[120:123]
    s_waitcnt lgkmcnt(6)
    v_mfma_f32_32x32x16_bf16 v[48:63], v[92:95], v[200:203], v[48:63]
    s_barrier
    ds_read_b64_tr_b16 v[80:81], v104 offset:0
    ds_read_b64_tr_b16 v[82:83], v104 offset:512
    s_waitcnt lgkmcnt(6)
    v_mfma_f32_32x32x16_bf16 v[64:79], v[96:99], v[200:203], v[64:79]
    ds_read_b64_tr_b16 v[84:85], v108 offset:0
    ds_read_b64_tr_b16 v[86:87], v108 offset:512
    s_lshr_b32 s15, s65, 2
    s_lshl_b32 s15, s15, 7
    s_sub_u32 s66, s60, 4
    s_lshl_b32 s17, s66, 11
    v_lshrrev_b32 v242, 2, v245
    v_and_b32 v242, 4, v242
    v_and_b32 v243, 7, v245
    v_xor_b32 v242, v242, v243
    v_lshrrev_b32 v243, 3, v245
    v_mul_u32_u24 v243, 896, v243
    v_lshl_add_u32 v242, v242, 4, v243
    v_add_u32 v243, 7168, v242
    s_and_b32 s75, s66, 1
    s_lshr_b32 s76, s66, 1
    s_and_b32 s83, s65, 3
    s_lshl2_add_u32 s67, s64, s83
    v_bfe_u32 v152, v245, 2, 2
    v_and_b32 v153, 11, v245
    v_lshlrev_b32 v153, 3, v153
    v_lshl_add_u32 v153, v152, 7, v153
    v_bfe_u32 v152, v245, 4, 1
    v_lshl_add_u32 v153, v152, 5, v153
    s_lshl_b32 s84, s76, 6
    s_add_u32 s83, s15, s84
    s_or_b32 s84, s84, s17
    v_lshrrev_b32 v154, 5, v245
    v_lshl_add_u32 v153, v154, 9, v153
    v_xor_b32 v138, s84, v153
    s_mul_i32 s84, s66, 172032
    s_add_u32 s84, s84, s15
    s_add_u32 s28, s84, 917504
    s_mul_i32 s84, s66, 229376
    s_add_u32 s29, s84, s15
    s_mul_i32 s84, s66, 12288
    s_lshl_b32 s85, s66, 14
    s_add_u32 s30, s84, 8978432
    s_add_u32 s31, s84, 8982528
    s_add_u32 s32, s84, 8986624
    s_add_u32 s33, s85, 8912896
    s_add_u32 s34, s85, 8916992
    s_add_u32 s35, s85, 8921088
    s_add_u32 s36, s85, 8925184
    s_mul_i32 s84, s66, 100352
    s_add_u32 s15, s15, s84
    s_lshl_b32 s16, s75, 11
    s_lshl1_add_u32 s84, s67, s75
    s_xor_b32 s85, s84, 1
    s_mul_i32 s86, s84, 114688
    v_add_u32 v136, s86, v244
    s_mul_i32 s86, s85, 114688
    v_add_u32 v137, s86, v244
    s_mul_i32 s86, s84, 28672
    s_add_u32 s86, s86, s83
    v_and_b32 v153, 31, v245
    v_mul_u32_u24 v153, 896, v153
    v_lshl_add_u32 v153, v154, 4, v153
    v_add_u32 v140, s86, v153
    s_lshl1_add_u32 s84, s84, s76
    s_lshl_b32 s84, s84, 14
    s_add_u32 s24, s84, 6815744
    s_add_u32 s25, s84, 6819840
    s_add_u32 s26, s84, 6823936
    s_add_u32 s27, s84, 6828032
    s_add_u32 s84, s17, 65536
    v_add_u32 v139, s84, v244
    v_and_b32 v153, 15, v245
    s_lshr_b32 s84, s67, 1
    s_lshl_b32 s85, s84, 11
    s_add_u32 s85, s85, 36864
    v_lshl_add_u32 v141, v153, 7, s85
    v_and_b32 v153, 3, v245
    v_lshl_add_u32 v153, v153, 3, v152
    s_lshl2_add_u32 s84, s84, s66
    s_and_b32 s85, s67, 1
    s_lshl4_add_u32 s84, s84, s85
    s_lshl_b32 s84, s84, 8
    s_add_u32 s84, s84, 262144
    v_lshl_add_u32 v142, v153, 7, s84
    s_waitcnt lgkmcnt(6)
    v_mfma_f32_32x32x16_bf16 v[48:63], v[128:131], v[204:207], v[48:63]
    ds_read_b64_tr_b16 v[92:93], v105 offset:0
    ds_read_b64_tr_b16 v[94:95], v105 offset:512
    s_waitcnt lgkmcnt(6)
    v_mfma_f32_32x32x16_bf16 v[64:79], v[132:135], v[204:207], v[64:79]
    ds_read_b64_tr_b16 v[96:97], v109 offset:0
    ds_read_b64_tr_b16 v[98:99], v109 offset:512
    s_waitcnt lgkmcnt(6)
    v_mfma_f32_32x32x16_bf16 v[48:63], v[80:83], v[208:211], v[48:63]
    ds_read_b64_tr_b16 v[128:129], v106 offset:0
    ds_read_b64_tr_b16 v[130:131], v106 offset:512
    v_mfma_f32_16x16x32_bf16 v[116:119], v[112:115], v[80:83], v[116:119]
    s_waitcnt lgkmcnt(6)
    v_mfma_f32_32x32x16_bf16 v[64:79], v[84:87], v[208:211], v[64:79]
    ds_read_b64_tr_b16 v[132:133], v110 offset:0
    ds_read_b64_tr_b16 v[134:135], v110 offset:512
    s_waitcnt lgkmcnt(6)
    v_mfma_f32_32x32x16_bf16 v[48:63], v[92:95], v[212:215], v[48:63]
    ds_read_b64_tr_b16 v[80:81], v107 offset:0
    ds_read_b64_tr_b16 v[82:83], v107 offset:512
    s_waitcnt lgkmcnt(6)
    v_mfma_f32_32x32x16_bf16 v[64:79], v[96:99], v[212:215], v[64:79]
    ds_read_b64_tr_b16 v[84:85], v111 offset:0
    ds_read_b64_tr_b16 v[86:87], v111 offset:512
    v_mfma_f32_16x16x32_bf16 v[120:123], v[112:115], v[96:99], v[120:123]
    s_waitcnt lgkmcnt(6)
    v_mfma_f32_32x32x16_bf16 v[48:63], v[128:131], v[216:219], v[48:63]
    ds_read_b64_tr_b16 v[92:93], v104 offset:40960
    ds_read_b64_tr_b16 v[94:95], v104 offset:41472
    s_waitcnt lgkmcnt(6)
    v_mfma_f32_32x32x16_bf16 v[64:79], v[132:135], v[216:219], v[64:79]
    ds_read_b64_tr_b16 v[96:97], v108 offset:40960
    ds_read_b64_tr_b16 v[98:99], v108 offset:41472
    s_waitcnt lgkmcnt(6)
    v_mfma_f32_32x32x16_bf16 v[48:63], v[80:83], v[220:223], v[48:63]
    ds_read_b64_tr_b16 v[128:129], v105 offset:40960
    ds_read_b64_tr_b16 v[130:131], v105 offset:41472
    s_waitcnt lgkmcnt(6)
    v_mfma_f32_32x32x16_bf16 v[64:79], v[84:87], v[220:223], v[64:79]
    ds_read_b64_tr_b16 v[132:133], v109 offset:40960
    ds_read_b64_tr_b16 v[134:135], v109 offset:41472
    s_lshl_b32 s82, s79, 2
    v_add_u32 v88, s82, v241
    s_waitcnt lgkmcnt(6)
    v_mfma_f32_32x32x16_bf16 v[48:63], v[92:95], v[224:227], v[48:63]
    ds_read_b64_tr_b16 v[80:81], v106 offset:40960
    ds_read_b64_tr_b16 v[82:83], v106 offset:41472
    v_mfma_f32_16x16x32_bf16 v[116:119], v[112:115], v[92:95], v[116:119]
    s_waitcnt lgkmcnt(6)
    v_mfma_f32_32x32x16_bf16 v[64:79], v[96:99], v[224:227], v[64:79]
    ds_read_b64_tr_b16 v[84:85], v110 offset:40960
    ds_read_b64_tr_b16 v[86:87], v110 offset:41472
    v_mfma_f32_16x16x32_bf16 v[120:123], v[112:115], v[96:99], v[120:123]
    s_waitcnt lgkmcnt(6)
    v_mfma_f32_32x32x16_bf16 v[48:63], v[128:131], v[228:231], v[48:63]
    ds_read_b64_tr_b16 v[92:93], v107 offset:40960
    ds_read_b64_tr_b16 v[94:95], v107 offset:41472
    s_waitcnt vmcnt(0)
    s_waitcnt lgkmcnt(6)
    v_mfma_f32_32x32x16_bf16 v[64:79], v[132:135], v[228:231], v[64:79]
    ds_write_b32 v88, v116 offset:0
    ds_write_b32 v88, v120 offset:1024
    ds_read_b64_tr_b16 v[96:97], v111 offset:40960
    ds_read_b64_tr_b16 v[98:99], v111 offset:41472
    s_waitcnt lgkmcnt(8)
    v_mfma_f32_32x32x16_bf16 v[48:63], v[80:83], v[232:235], v[48:63]
    s_waitcnt lgkmcnt(2)
    s_barrier
    ds_read_b128 v[116:119], v241 offset:0
    ds_read_b128 v[120:123], v241 offset:1024
    v_mfma_f32_32x32x16_bf16 v[64:79], v[84:87], v[232:235], v[64:79]
    s_cmp_eq_u32 s60, 4
    s_cbranch_scc0 L_f3
    s_mov_b64 exec, 1
    buffer_store_dword v246, v244, s[44:47], s11 offen sc1
    s_mov_b64 exec, -1
L_f3:
    s_waitcnt lgkmcnt(1)
    v_add_f32 v116, v116, v117
    v_add_f32 v118, v118, v119
    v_add_f32 v116, v116, v118
    v_and_b32 v117, s74, v116
    v_lshrrev_b32 v253, 16, v116
    v_sub_f32 v118, v116, v117
    v_cvt_pk_bf16_f32 v252, v117, v118
    s_nop 1
    v_mfma_f32_32x32x16_bf16 v[48:63], v[252:255], v[248:251], v[48:63]
    v_mfma_f32_32x32x16_bf16 v[48:63], v[92:95], v[236:239], v[48:63]
    s_waitcnt lgkmcnt(0)
    v_add_f32 v120, v120, v121
    v_add_f32 v122, v122, v123
    v_add_f32 v120, v120, v122
    v_and_b32 v121, s74, v120
    v_lshrrev_b32 v253, 16, v120
    v_sub_f32 v122, v120, v121
    v_cvt_pk_bf16_f32 v252, v121, v122
    s_nop 1
    v_mfma_f32_32x32x16_bf16 v[64:79], v[252:255], v[248:251], v[64:79]
    v_mfma_f32_32x32x16_bf16 v[64:79], v[96:99], v[236:239], v[64:79]
    s_barrier
    v_max_f32 v48, 0, v48
    v_mul_f32 v56, v240, v56
    v_mul_f32 v48, v48, v56
    v_max_f32 v49, 0, v49
    v_mul_f32 v57, v240, v57
    v_mul_f32 v49, v49, v57
    v_max_f32 v50, 0, v50
    v_mul_f32 v58, v240, v58
    v_mul_f32 v50, v50, v58
    v_max_f32 v51, 0, v51
    v_mul_f32 v59, v240, v59
    v_mul_f32 v51, v51, v59
    v_max_f32 v52, 0, v52
    v_mul_f32 v60, v240, v60
    v_mul_f32 v52, v52, v60
    v_max_f32 v53, 0, v53
    v_mul_f32 v61, v240, v61
    v_mul_f32 v53, v53, v61
    v_max_f32 v54, 0, v54
    v_mul_f32 v62, v240, v62
    v_mul_f32 v54, v54, v62
    v_max_f32 v55, 0, v55
    v_mul_f32 v63, v240, v63
    v_mul_f32 v55, v55, v63
    v_cvt_pk_bf16_f32 v128, v48, v49
    v_cvt_pk_bf16_f32 v129, v50, v51
    v_cvt_pk_bf16_f32 v130, v52, v53
    v_cvt_pk_bf16_f32 v131, v54, v55
    v_max_f32 v64, 0, v64
    v_mul_f32 v72, v240, v72
    v_mul_f32 v64, v64, v72
    v_max_f32 v65, 0, v65
    v_mul_f32 v73, v240, v73
    v_mul_f32 v65, v65, v73
    v_max_f32 v66, 0, v66
    v_mul_f32 v74, v240, v74
    v_mul_f32 v66, v66, v74
    v_max_f32 v67, 0, v67
    v_mul_f32 v75, v240, v75
    v_mul_f32 v67, v67, v75
    v_max_f32 v68, 0, v68
    v_mul_f32 v76, v240, v76
    v_mul_f32 v68, v68, v76
    v_max_f32 v69, 0, v69
    v_mul_f32 v77, v240, v77
    v_mul_f32 v69, v69, v77
    v_max_f32 v70, 0, v70
    v_mul_f32 v78, v240, v78
    v_mul_f32 v70, v70, v78
    v_max_f32 v71, 0, v71
    v_mul_f32 v79, v240, v79
    v_mul_f32 v71, v71, v79
    v_cvt_pk_bf16_f32 v132, v64, v65
    v_cvt_pk_bf16_f32 v133, v66, v67
    v_cvt_pk_bf16_f32 v134, v68, v69
    v_cvt_pk_bf16_f32 v135, v70, v71
    s_add_u32 s82, s79, 1
    s_and_b32 s82, s82, 3
    s_lshl_b32 s82, s82, 12
    s_add_u32 s82, s82, 114688
    v_add_u32 v88, s82, v244
    ds_write_b128 v88, v[128:131] offset:0
    ds_write_b128 v88, v[132:135] offset:1024
    v_mov_b32 v232, v136
    v_mov_b32 v233, v137
    v_mov_b32 v234, v138
    v_mov_b32 v240, v139
    v_mov_b32 v241, v140
    v_mov_b32 v247, v141
    v_mov_b32 v254, v142
    v_xor_b32 v235, 64, v234
    v_add_u32 v236, 57344, v234
    v_add_u32 v237, 57344, v235
    s_waitcnt lgkmcnt(0)
    s_barrier
    s_cmp_ge_u32 s65, 28
    s_cbranch_scc1 L_idle
    s_setprio 0
    s_add_u32 m0, s17, 0
    s_waitcnt vmcnt(5)
    buffer_load_dwordx4 v242, s[48:51], s28 offen lds
    s_add_u32 m0, s17, 1024
    s_waitcnt vmcnt(5)
    buffer_load_dwordx4 v243, s[48:51], s28 offen lds
    s_add_u32 s28, s28, 14336
    s_add_u32 m0, s17, 8192
    s_waitcnt vmcnt(5)
    buffer_load_dwordx4 v242, s[48:51], s28 offen lds
    s_add_u32 m0, s17, 9216
    s_waitcnt vmcnt(5)
    buffer_load_dwordx4 v243, s[48:51], s28 offen lds
    s_add_u32 s28, s28, 14336
    s_add_u32 m0, s17, 16384
    s_waitcnt vmcnt(5)
    buffer_load_dwordx4 v242, s[48:51], s28 offen lds
    s_add_u32 m0, s17, 17408
    s_waitcnt vmcnt(5)
    buffer_load_dwordx4 v243, s[48:51], s28 offen lds
    s_add_u32 s28, s28, 14336
    s_add_u32 m0, s17, 24576
    s_waitcnt vmcnt(5)
    buffer_load_dwordx4 v242, s[48:51], s28 offen lds
    s_add_u32 m0, s17, 25600
    s_waitcnt vmcnt(5)
    buffer_load_dwordx4 v243, s[48:51], s28 offen lds
    s_add_u32 s28, s28, 14336
    s_add_u32 m0, s17, 32768
    s_waitcnt vmcnt(4)
    buffer_load_dwordx4 v242, s[48:51], s28 offen lds
    s_add_u32 m0, s17, 33792
    s_waitcnt vmcnt(4)
    buffer_load_dwordx4 v243, s[48:51], s28 offen lds
    s_add_u32 s28, s28, 14336
    s_add_u32 m0, s17, 40960
    s_waitcnt vmcnt(4)
    buffer_load_dwordx4 v242, s[48:51], s28 offen lds
    s_add_u32 m0, s17, 41984
    s_waitcnt vmcnt(4)
    buffer_load_dwordx4 v243, s[48:51], s28 offen lds
    s_add_u32 s28, s28, 14336
    s_add_u32 m0, s17, 49152
    s_waitcnt vmcnt(4)
    buffer_load_dwordx4 v242, s[48:51], s28 offen lds
    s_add_u32 m0, s17, 50176
    s_waitcnt vmcnt(4)
    buffer_load_dwordx4 v243, s[48:51], s28 offen lds
    s_add_u32 s28, s28, 14336
    buffer_load_dword v208, v247, s[44:47], 0 offen sc1
    s_add_u32 m0, s17, 57344
    s_waitcnt vmcnt(4)
    buffer_load_dwordx4 v242, s[48:51], s28 offen lds
    s_add_u32 m0, s17, 58368
    s_waitcnt vmcnt(4)
    buffer_load_dwordx4 v243, s[48:51], s28 offen lds
    s_add_u32 s28, s28, 14336
    s_add_u32 m0, s17, 65536
    s_waitcnt vmcnt(4)
    buffer_load_dwordx4 v242, s[48:51], s28 offen lds
    s_add_u32 m0, s17, 66560
    s_waitcnt vmcnt(4)
    buffer_load_dwordx4 v243, s[48:51], s28 offen lds
    s_add_u32 s28, s28, 14336
    s_waitcnt vmcnt(4)
    v_cmp_ne_u32 vcc, s63, v208
    s_nop 2
    s_cbranch_vccz L_phok
    s_mov_b32 s87, 0
L_ph:
    buffer_load_dword v208, v247, s[44:47], 0 offen sc1
    s_add_u32 s87, s87, 1
    s_waitcnt vmcnt(0)
    v_cmp_ne_u32 vcc, s63, v208
    s_cmp_lt_u32 s87, 100000
    s_cselect_b64 s[84:85], -1, 0
    s_nop 0
    s_and_b64 vcc, vcc, s[84:85]
    s_cbranch_vccnz L_ph
L_phok:
    s_waitcnt vmcnt(4)
    buffer_load_dwordx4 v[64:67], v232, s[44:47], s30 offen offset:0 sc1
    s_waitcnt vmcnt(4)
    buffer_load_dwordx4 v[68:71], v233, s[44:47], s30 offen offset:0 sc1
    s_add_u32 m0, s17, 73728
    s_waitcnt vmcnt(4)
    buffer_load_dwordx4 v242, s[48:51], s28 offen lds
    s_add_u32 m0, s17, 74752
    s_waitcnt vmcnt(4)
    buffer_load_dwordx4 v243, s[48:51], s28 offen lds
    s_add_u32 s28, s28, 14336
    s_waitcnt vmcnt(4)
    buffer_load_dwordx4 v[72:75], v232, s[44:47], s30 offen offset:1024 sc1
    s_waitcnt vmcnt(4)
    buffer_load_dwordx4 v[76:79], v233, s[44:47], s30 offen offset:1024 sc1
    s_add_u32 m0, s17, 81920
    s_waitcnt vmcnt(4)
    buffer_load_dwordx4 v242, s[48:51], s28 offen lds
    s_add_u32 m0, s17, 82944
    s_waitcnt vmcnt(4)
    buffer_load_dwordx4 v243, s[48:51], s28 offen lds
    s_add_u32 s28, s28, 14336
    s_waitcnt vmcnt(4)
    buffer_load_dwordx4 v[80:83], v232, s[44:47], s30 offen offset:2048 sc1
    s_waitcnt vmcnt(4)
    buffer_load_dwordx4 v[84:87], v233, s[44:47], s30 offen offset:2048 sc1
    s_add_u32 m0, s17, 90112
    s_waitcnt vmcnt(4)
    buffer_load_dwordx4 v242, s[48:51], s28 offen lds
    s_add_u32 m0, s17, 91136
    s_waitcnt vmcnt(4)
    buffer_load_dwordx4 v243, s[48:51], s28 offen lds
    s_add_u32 s28, s28, 14336
    s_waitcnt vmcnt(4)
    buffer_load_dwordx4 v[88:91], v232, s[44:47], s30 offen offset:3072 sc1
    s_waitcnt vmcnt(4)
    buffer_load_dwordx4 v[92:95], v233, s[44:47], s30 offen offset:3072 sc1
    s_add_u32 m0, s17, 98304
    s_waitcnt vmcnt(4)
    buffer_load_dwordx4 v242, s[48:51], s29 offen lds
    s_add_u32 m0, s17, 99328
    s_waitcnt vmcnt(4)
    buffer_load_dwordx4 v243, s[48:51], s29 offen lds
    s_add_u32 s29, s29, 14336
    s_waitcnt vmcnt(4)
    buffer_load_dwordx4 v[96:99], v232, s[44:47], s31 offen offset:0 sc1
    s_waitcnt vmcnt(4)
    buffer_load_dwordx4 v[100:103], v233, s[44:47], s31 offen offset:0 sc1
    s_add_u32 m0, s17, 106496
    s_waitcnt vmcnt(4)
    buffer_load_dwordx4 v242, s[48:51], s29 offen lds
    s_add_u32 m0, s17, 107520
    s_waitcnt vmcnt(4)
    buffer_load_dwordx4 v243, s[48:51], s29 offen lds
    s_add_u32 s29, s29, 14336
    s_waitcnt vmcnt(4)
    buffer_load_dwordx4 v[104:107], v232, s[44:47], s31 offen offset:1024 sc1
    s_waitcnt vmcnt(4)
    buffer_load_dwordx4 v[108:111], v233, s[44:47], s31 offen offset:1024 sc1
    s_waitcnt vmcnt(4)
    buffer_load_dwordx4 v[112:115], v232, s[44:47], s31 offen offset:2048 sc1
    s_waitcnt vmcnt(4)
    buffer_load_dwordx4 v[116:119], v233, s[44:47], s31 offen offset:2048 sc1
    s_waitcnt vmcnt(4)
    buffer_load_dwordx4 v[120:123], v232, s[44:47], s31 offen offset:3072 sc1
    s_waitcnt vmcnt(4)
    buffer_load_dwordx4 v[124:127], v233, s[44:47], s31 offen offset:3072 sc1
    s_waitcnt vmcnt(4)
    buffer_load_dwordx4 v[128:131], v232, s[44:47], s32 offen offset:0 sc1
    s_waitcnt vmcnt(4)
    buffer_load_dwordx4 v[132:135], v233, s[44:47], s32 offen offset:0 sc1
    s_waitcnt vmcnt(4)
    buffer_load_dwordx4 v[224:227], v241, s[20:23], 0 offen offset:0
    s_waitcnt vmcnt(4)
    buffer_load_dwordx4 v[228:231], v241, s[20:23], 0 offen offset:32
    s_waitcnt vmcnt(4)
    buffer_load_dwordx4 v[136:139], v232, s[44:47], s32 offen offset:1024 sc1
    s_waitcnt vmcnt(4)
    buffer_load_dwordx4 v[140:143], v233, s[44:47], s32 offen offset:1024 sc1
    s_waitcnt vmcnt(4)
    buffer_load_dwordx4 v[144:147], v232, s[44:47], s32 offen offset:2048 sc1
    s_waitcnt vmcnt(4)
    buffer_load_dwordx4 v[148:151], v233, s[44:47], s32 offen offset:2048 sc1
    s_waitcnt vmcnt(4)
    buffer_load_dwordx4 v[152:155], v232, s[44:47], s32 offen offset:3072 sc1
    s_waitcnt vmcnt(4)
    buffer_load_dwordx4 v[156:159], v233, s[44:47], s32 offen offset:3072 sc1
    ds_read_b64_tr_b16 v[208:209], v234 offset:0
    ds_read_b64_tr_b16 v[210:211], v234 offset:1024
    ds_read_b64_tr_b16 v[212:213], v235 offset:0
    ds_read_b64_tr_b16 v[214:215], v235 offset:1024
    s_setprio 3
    v_permlane32_swap_b32 v224, v226
    v_permlane32_swap_b32 v225, v227
    v_permlane32_swap_b32 v228, v230
    v_permlane32_swap_b32 v229, v231
    v_lshlrev_b32 v0, 16, v224
    v_and_b32 v1, s74, v224
    v_lshlrev_b32 v2, 16, v225
    v_and_b32 v3, s74, v225
    v_lshlrev_b32 v4, 16, v226
    v_and_b32 v5, s74, v226
    v_lshlrev_b32 v6, 16, v227
    v_and_b32 v7, s74, v227
    v_lshlrev_b32 v8, 16, v228
    v_and_b32 v9, s74, v228
    v_lshlrev_b32 v10, 16, v229
    v_and_b32 v11, s74, v229
    v_lshlrev_b32 v12, 16, v230
    v_and_b32 v13, s74, v230
    v_lshlrev_b32 v14, 16, v231
    v_and_b32 v15, s74, v231
    s_setprio 0
    buffer_load_dword v253, v254, s[44:47], 0 offen sc1
    s_waitcnt lgkmcnt(2)
    v_mfma_f32_32x32x16_bf16 v[32:47], v[208:211], v[68:71], 0
    ds_read_b64_tr_b16 v[216:217], v234 offset:8192
    ds_read_b64_tr_b16 v[218:219], v234 offset:9216
    ds_read_b64_tr_b16 v[220:221], v235 offset:8192
    ds_read_b64_tr_b16 v[222:223], v235 offset:9216
    s_add_u32 m0, s17, 0
    s_waitcnt lgkmcnt(4)
    v_mfma_f32_32x32x16_bf16 v[48:63], v[212:215], v[68:71], 0
    s_waitcnt vmcnt(6)
    buffer_load_dwordx4 v242, s[48:51], s29 offen lds
    s_add_u32 m0, s17, 1024
    v_mfma_f32_32x32x16_bf16 v[0:15], v[208:211], v[64:67], v[0:15]
    s_waitcnt vmcnt(6)
    buffer_load_dwordx4 v243, s[48:51], s29 offen lds
    s_add_u32 s29, s29, 14336
    v_mfma_f32_32x32x16_bf16 v[16:31], v[212:215], v[64:67], 0
    s_waitcnt lgkmcnt(2)
    v_mfma_f32_32x32x16_bf16 v[32:47], v[216:219], v[76:79], v[32:47]
    ds_read_b64_tr_b16 v[208:209], v234 offset:16384
    ds_read_b64_tr_b16 v[210:211], v234 offset:17408
    ds_read_b64_tr_b16 v[212:213], v235 offset:16384
    ds_read_b64_tr_b16 v[214:215], v235 offset:17408
    s_add_u32 m0, s17, 8192
    s_waitcnt lgkmcnt(4)
    v_mfma_f32_32x32x16_bf16 v[48:63], v[220:223], v[76:79], v[48:63]
    s_waitcnt vmcnt(6)
    buffer_load_dwordx4 v242, s[48:51], s29 offen lds
    s_add_u32 m0, s17, 9216
    v_mfma_f32_32x32x16_bf16 v[0:15], v[216:219], v[72:75], v[0:15]
    s_waitcnt vmcnt(6)
    buffer_load_dwordx4 v243, s[48:51], s29 offen lds
    s_add_u32 s29, s29, 14336
    v_mfma_f32_32x32x16_bf16 v[16:31], v[220:223], v[72:75], v[16:31]
    s_waitcnt vmcnt(4)
    v_cmp_ne_u32 vcc, s63, v253
    s_nop 2
    s_cbranch_vccz L_pgok
    s_mov_b32 s87, 0
L_pg:
    buffer_load_dword v253, v254, s[44:47], 0 offen sc1
    s_add_u32 s87, s87, 1
    s_waitcnt vmcnt(0)
    v_cmp_ne_u32 vcc, s63, v253
    s_cmp_lt_u32 s87, 100000
    s_cselect_b64 s[84:85], -1, 0
    s_nop 0
    s_and_b64 vcc, vcc, s[84:85]
    s_cbranch_vccnz L_pg
L_pgok:
    s_waitcnt vmcnt(4)
    buffer_load_dwordx4 v[160:163], v232, s[44:47], s33 offen offset:0 sc1
    s_waitcnt vmcnt(4)
    buffer_load_dwordx4 v[164:167], v233, s[44:47], s33 offen offset:0 sc1
    s_waitcnt vmcnt(4)
    buffer_load_dwordx4 v[168:171], v232, s[44:47], s33 offen offset:1024 sc1
    s_waitcnt vmcnt(4)
    buffer_load_dwordx4 v[172:175], v233, s[44:47], s33 offen offset:1024 sc1
    s_waitcnt vmcnt(4)
    buffer_load_dwordx4 v[176:179], v232, s[44:47], s33 offen offset:2048 sc1
    s_waitcnt vmcnt(4)
    buffer_load_dwordx4 v[180:183], v233, s[44:47], s33 offen offset:2048 sc1
    s_waitcnt vmcnt(4)
    buffer_load_dwordx4 v[184:187], v232, s[44:47], s33 offen offset:3072 sc1
    s_waitcnt vmcnt(4)
    buffer_load_dwordx4 v[188:191], v233, s[44:47], s33 offen offset:3072 sc1
    s_waitcnt vmcnt(4)
    buffer_load_dwordx4 v[192:195], v232, s[44:47], s34 offen offset:0 sc1
    s_waitcnt vmcnt(4)
    buffer_load_dwordx4 v[196:199], v233, s[44:47], s34 offen offset:0 sc1
    s_waitcnt vmcnt(4)
    buffer_load_dwordx4 v[200:203], v232, s[44:47], s34 offen offset:1024 sc1
    s_waitcnt vmcnt(4)
    buffer_load_dwordx4 v[204:207], v233, s[44:47], s34 offen offset:1024 sc1
    s_waitcnt vmcnt(4)
    buffer_load_dwordx4 v[64:67], v232, s[44:47], s34 offen offset:2048 sc1
    s_waitcnt vmcnt(4)
    buffer_load_dwordx4 v[68:71], v233, s[44:47], s34 offen offset:2048 sc1
    s_waitcnt vmcnt(4)
    buffer_load_dwordx4 v[72:75], v232, s[44:47], s34 offen offset:3072 sc1
    s_waitcnt vmcnt(4)
    buffer_load_dwordx4 v[76:79], v233, s[44:47], s34 offen offset:3072 sc1
    s_waitcnt lgkmcnt(2)
    v_mfma_f32_32x32x16_bf16 v[32:47], v[208:211], v[84:87], v[32:47]
    ds_read_b64_tr_b16 v[216:217], v234 offset:24576
    ds_read_b64_tr_b16 v[218:219], v234 offset:25600
    ds_read_b64_tr_b16 v[220:221], v235 offset:24576
    ds_read_b64_tr_b16 v[222:223], v235 offset:25600
    s_add_u32 m0, s17, 16384
    s_waitcnt lgkmcnt(4)
    v_mfma_f32_32x32x16_bf16 v[48:63], v[212:215], v[84:87], v[48:63]
    s_waitcnt vmcnt(6)
    buffer_load_dwordx4 v242, s[48:51], s29 offen lds
    s_add_u32 m0, s17, 17408
    v_mfma_f32_32x32x16_bf16 v[0:15], v[208:211], v[80:83], v[0:15]
    s_waitcnt vmcnt(6)
    buffer_load_dwordx4 v243, s[48:51], s29 offen lds
    s_add_u32 s29, s29, 14336
    v_mfma_f32_32x32x16_bf16 v[16:31], v[212:215], v[80:83], v[16:31]
    s_waitcnt vmcnt(6)
    buffer_load_dwordx4 v[80:83], v232, s[44:47], s35 offen offset:0 sc1
    s_waitcnt vmcnt(6)
    buffer_load_dwordx4 v[84:87], v233, s[44:47], s35 offen offset:0 sc1
    s_waitcnt lgkmcnt(2)
    v_mfma_f32_32x32x16_bf16 v[32:47], v[216:219], v[92:95], v[32:47]
    ds_read_b64_tr_b16 v[208:209], v234 offset:32768
    ds_read_b64_tr_b16 v[210:211], v234 offset:33792
    ds_read_b64_tr_b16 v[212:213], v235 offset:32768
    ds_read_b64_tr_b16 v[214:215], v235 offset:33792
    s_add_u32 m0, s17, 24576
    s_waitcnt lgkmcnt(4)
    v_mfma_f32_32x32x16_bf16 v[48:63], v[220:223], v[92:95], v[48:63]
    s_waitcnt vmcnt(6)
    buffer_load_dwordx4 v242, s[48:51], s29 offen lds
    s_add_u32 m0, s17, 25600
    v_mfma_f32_32x32x16_bf16 v[0:15], v[216:219], v[88:91], v[0:15]
    s_waitcnt vmcnt(6)
    buffer_load_dwordx4 v243, s[48:51], s29 offen lds
    s_add_u32 s29, s29, 14336
    v_mfma_f32_32x32x16_bf16 v[16:31], v[220:223], v[88:91], v[16:31]
    s_waitcnt vmcnt(6)
    buffer_load_dwordx4 v[88:91], v232, s[44:47], s35 offen offset:1024 sc1
    s_waitcnt vmcnt(6)
    buffer_load_dwordx4 v[92:95], v233, s[44:47], s35 offen offset:1024 sc1
    s_waitcnt lgkmcnt(2)
    v_mfma_f32_32x32x16_bf16 v[32:47], v[208:211], v[100:103], v[32:47]
    ds_read_b64_tr_b16 v[216:217], v234 offset:40960
    ds_read_b64_tr_b16 v[218:219], v234 offset:41984
    ds_read_b64_tr_b16 v[220:221], v235 offset:40960
    ds_read_b64_tr_b16 v[222:223], v235 offset:41984
    s_add_u32 m0, s17, 32768
    s_waitcnt lgkmcnt(4)
    v_mfma_f32_32x32x16_bf16 v[48:63], v[212:215], v[100:103], v[48:63]
    s_waitcnt vmcnt(6)
    buffer_load_dwordx4 v242, s[48:51], s29 offen lds
    s_add_u32 m0, s17, 33792
    v_mfma_f32_32x32x16_bf16 v[0:15], v[208:211], v[96:99], v[0:15]
    s_waitcnt vmcnt(6)
    buffer_load_dwordx4 v243, s[48:51], s29 offen lds
    s_add_u32 s29, s29, 14336
    v_mfma_f32_32x32x16_bf16 v[16:31], v[212:215], v[96:99], v[16:31]
    s_waitcnt vmcnt(6)
    buffer_load_dwordx4 v[96:99], v232, s[44:47], s35 offen offset:2048 sc1
    s_waitcnt vmcnt(6)
    buffer_load_dwordx4 v[100:103], v233, s[44:47], s35 offen offset:2048 sc1
    s_waitcnt lgkmcnt(2)
    v_mfma_f32_32x32x16_bf16 v[32:47], v[216:219], v[108:111], v[32:47]
    ds_read_b64_tr_b16 v[208:209], v234 offset:49152
    ds_read_b64_tr_b16 v[210:211], v234 offset:50176
    ds_read_b64_tr_b16 v[212:213], v235 offset:49152
    ds_read_b64_tr_b16 v[214:215], v235 offset:50176
    s_add_u32 m0, s17, 40960
    s_waitcnt lgkmcnt(4)
    v_mfma_f32_32x32x16_bf16 v[48:63], v[220:223], v[108:111], v[48:63]
    s_waitcnt vmcnt(6)
    buffer_load_dwordx4 v242, s[48:51], s29 offen lds
    s_add_u32 m0, s17, 41984
    v_mfma_f32_32x32x16_bf16 v[0:15], v[216:219], v[104:107], v[0:15]
    s_waitcnt vmcnt(6)
    buffer_load_dwordx4 v243, s[48:51], s29 offen lds
    s_add_u32 s29, s29, 14336
    v_mfma_f32_32x32x16_bf16 v[16:31], v[220:223], v[104:107], v[16:31]
    s_waitcnt vmcnt(6)
    buffer_load_dwordx4 v[104:107], v232, s[44:47], s35 offen offset:3072 sc1
    s_waitcnt vmcnt(6)
    buffer_load_dwordx4 v[108:111], v233, s[44:47], s35 offen offset:3072 sc1
    s_waitcnt lgkmcnt(2)
    v_mfma_f32_32x32x16_bf16 v[32:47], v[208:211], v[116:119], v[32:47]
    ds_read_b64_tr_b16 v[216:217], v236 offset:0
    ds_read_b64_tr_b16 v[218:219], v236 offset:1024
    ds_read_b64_tr_b16 v[220:221], v237 offset:0
    ds_read_b64_tr_b16 v[222:223], v237 offset:1024
    s_add_u32 m0, s17, 49152
    s_waitcnt lgkmcnt(4)
    v_mfma_f32_32x32x16_bf16 v[48:63], v[212:215], v[116:119], v[48:63]
    s_waitcnt vmcnt(6)
    buffer_load_dwordx4 v242, s[48:51], s29 offen lds
    s_add_u32 m0, s17, 50176
    v_mfma_f32_32x32x16_bf16 v[0:15], v[208:211], v[112:115], v[0:15]
    s_waitcnt vmcnt(6)
    buffer_load_dwordx4 v243, s[48:51], s29 offen lds
    s_add_u32 s29, s29, 14336
    v_mfma_f32_32x32x16_bf16 v[16:31], v[212:215], v[112:115], v[16:31]
    s_waitcnt vmcnt(6)
    buffer_load_dwordx4 v[112:115], v232, s[44:47], s36 offen offset:0 sc1
    s_waitcnt vmcnt(6)
    buffer_load_dwordx4 v[116:119], v233, s[44:47], s36 offen offset:0 sc1
    s_waitcnt lgkmcnt(2)
    v_mfma_f32_32x32x16_bf16 v[32:47], v[216:219], v[124:127], v[32:47]
    ds_read_b64_tr_b16 v[208:209], v236 offset:8192
    ds_read_b64_tr_b16 v[210:211], v236 offset:9216
    ds_read_b64_tr_b16 v[212:213], v237 offset:8192
    ds_read_b64_tr_b16 v[214:215], v237 offset:9216
    s_add_u32 m0, s17, 57344
    s_waitcnt lgkmcnt(4)
    v_mfma_f32_32x32x16_bf16 v[48:63], v[220:223], v[124:127], v[48:63]
    s_waitcnt vmcnt(6)
    buffer_load_dwordx4 v242, s[48:51], s29 offen lds
    s_add_u32 m0, s17, 58368
    v_mfma_f32_32x32x16_bf16 v[0:15], v[216:219], v[120:123], v[0:15]
    s_waitcnt vmcnt(6)
    buffer_load_dwordx4 v243, s[48:51], s29 offen lds
    s_add_u32 s29, s29, 14336
    v_mfma_f32_32x32x16_bf16 v[16:31], v[220:223], v[120:123], v[16:31]
    s_waitcnt vmcnt(6)
    buffer_load_dwordx4 v[120:123], v232, s[44:47], s36 offen offset:1024 sc1
    s_waitcnt vmcnt(6)
    buffer_load_dwordx4 v[124:127], v233, s[44:47], s36 offen offset:1024 sc1
    s_waitcnt lgkmcnt(2)
    v_mfma_f32_32x32x16_bf16 v[32:47], v[208:211], v[132:135], v[32:47]
    ds_read_b64_tr_b16 v[216:217], v236 offset:16384
    ds_read_b64_tr_b16 v[218:219], v236 offset:17408
    ds_read_b64_tr_b16 v[220:221], v237 offset:16384
    ds_read_b64_tr_b16 v[222:223], v237 offset:17408
    s_add_u32 m0, s17, 65536
    s_waitcnt lgkmcnt(4)
    v_mfma_f32_32x32x16_bf16 v[48:63], v[212:215], v[132:135], v[48:63]
    s_waitcnt vmcnt(6)
    buffer_load_dwordx4 v242, s[48:51], s29 offen lds
    s_add_u32 m0, s17, 66560
    v_mfma_f32_32x32x16_bf16 v[0:15], v[208:211], v[128:131], v[0:15]
    s_waitcnt vmcnt(6)
    buffer_load_dwordx4 v243, s[48:51], s29 offen lds
    s_add_u32 s29, s29, 14336
    v_mfma_f32_32x32x16_bf16 v[16:31], v[212:215], v[128:131], v[16:31]
    s_waitcnt vmcnt(6)
    buffer_load_dwordx4 v[128:131], v232, s[44:47], s36 offen offset:2048 sc1
    s_waitcnt vmcnt(6)
    buffer_load_dwordx4 v[132:135], v233, s[44:47], s36 offen offset:2048 sc1
    s_waitcnt lgkmcnt(2)
    v_mfma_f32_32x32x16_bf16 v[32:47], v[216:219], v[140:143], v[32:47]
    ds_read_b64_tr_b16 v[208:209], v236 offset:24576
    ds_read_b64_tr_b16 v[210:211], v236 offset:25600
    ds_read_b64_tr_b16 v[212:213], v237 offset:24576
    ds_read_b64_tr_b16 v[214:215], v237 offset:25600
    s_add_u32 m0, s17, 73728
    s_waitcnt lgkmcnt(4)
    v_mfma_f32_32x32x16_bf16 v[48:63], v[220:223], v[140:143], v[48:63]
    s_waitcnt vmcnt(6)
    buffer_load_dwordx4 v242, s[48:51], s29 offen lds
    s_add_u32 m0, s17, 74752
    v_mfma_f32_32x32x16_bf16 v[0:15], v[216:219], v[136:139], v[0:15]
    s_waitcnt vmcnt(6)
    buffer_load_dwordx4 v243, s[48:51], s29 offen lds
    s_add_u32 s29, s29, 14336
    v_mfma_f32_32x32x16_bf16 v[16:31], v[220:223], v[136:139], v[16:31]
    s_waitcnt vmcnt(6)
    buffer_load_dwordx4 v[136:139], v232, s[44:47], s36 offen offset:3072 sc1
    s_waitcnt vmcnt(6)
    buffer_load_dwordx4 v[140:143], v233, s[44:47], s36 offen offset:3072 sc1
    s_waitcnt lgkmcnt(2)
    v_mfma_f32_32x32x16_bf16 v[32:47], v[208:211], v[148:151], v[32:47]
    ds_read_b64_tr_b16 v[216:217], v236 offset:32768
    ds_read_b64_tr_b16 v[218:219], v236 offset:33792
    ds_read_b64_tr_b16 v[220:221], v237 offset:32768
    ds_read_b64_tr_b16 v[222:223], v237 offset:33792
    s_add_u32 m0, s17, 81920
    s_waitcnt lgkmcnt(4)
    v_mfma_f32_32x32x16_bf16 v[48:63], v[212:215], v[148:151], v[48:63]
    s_waitcnt vmcnt(6)
    buffer_load_dwordx4 v242, s[48:51], s29 offen lds
    s_add_u32 m0, s17, 82944
    v_mfma_f32_32x32x16_bf16 v[0:15], v[208:211], v[144:147], v[0:15]
    s_waitcnt vmcnt(6)
    buffer_load_dwordx4 v243, s[48:51], s29 offen lds
    s_add_u32 s29, s29, 14336
    v_mfma_f32_32x32x16_bf16 v[16:31], v[212:215], v[144:147], v[16:31]
    s_waitcnt lgkmcnt(2)
    v_mfma_f32_32x32x16_bf16 v[32:47], v[216:219], v[156:159], v[32:47]
    ds_read_b64_tr_b16 v[208:209], v236 offset:40960
    ds_read_b64_tr_b16 v[210:211], v236 offset:41984
    ds_read_b64_tr_b16 v[212:213], v237 offset:40960
    ds_read_b64_tr_b16 v[214:215], v237 offset:41984
    s_add_u32 m0, s17, 90112
    s_waitcnt lgkmcnt(4)
    v_mfma_f32_32x32x16_bf16 v[48:63], v[220:223], v[156:159], v[48:63]
    s_waitcnt vmcnt(6)
    buffer_load_dwordx4 v242, s[48:51], s29 offen lds
    s_add_u32 m0, s17, 91136
    v_mfma_f32_32x32x16_bf16 v[0:15], v[216:219], v[152:155], v[0:15]
    s_waitcnt vmcnt(6)
    buffer_load_dwordx4 v243, s[48:51], s29 offen lds
    s_add_u32 s29, s29, 14336
    v_mfma_f32_32x32x16_bf16 v[16:31], v[220:223], v[152:155], v[16:31]
    s_waitcnt lgkmcnt(2)
    v_mfma_f32_32x32x16_bf16 v[32:47], v[208:211], v[164:167], v[32:47]
    ds_read_b64_tr_b16 v[216:217], v236 offset:49152
    ds_read_b64_tr_b16 v[218:219], v236 offset:50176
    ds_read_b64_tr_b16 v[220:221], v237 offset:49152
    ds_read_b64_tr_b16 v[222:223], v237 offset:50176
    s_add_u32 m0, s17, 98304
    s_waitcnt lgkmcnt(4)
    v_mfma_f32_32x32x16_bf16 v[48:63], v[212:215], v[164:167], v[48:63]
    buffer_load_dwordx4 v242, s[48:51], s29 offen lds
    s_add_u32 m0, s17, 99328
    v_mfma_f32_32x32x16_bf16 v[0:15], v[208:211], v[160:163], v[0:15]
    buffer_load_dwordx4 v243, s[48:51], s29 offen lds
    s_add_u32 s29, s29, 14336
    v_mfma_f32_32x32x16_bf16 v[16:31], v[212:215], v[160:163], v[16:31]
    s_waitcnt lgkmcnt(2)
    v_mfma_f32_32x32x16_bf16 v[32:47], v[216:219], v[172:175], v[32:47]
    ds_read_b64_tr_b16 v[208:209], v234 offset:0
    ds_read_b64_tr_b16 v[210:211], v234 offset:1024
    ds_read_b64_tr_b16 v[212:213], v235 offset:0
    ds_read_b64_tr_b16 v[214:215], v235 offset:1024
    s_add_u32 m0, s17, 106496
    s_waitcnt lgkmcnt(4)
    v_mfma_f32_32x32x16_bf16 v[48:63], v[220:223], v[172:175], v[48:63]
    buffer_load_dwordx4 v242, s[48:51], s29 offen lds
    s_add_u32 m0, s17, 107520
    v_mfma_f32_32x32x16_bf16 v[0:15], v[216:219], v[168:171], v[0:15]
    buffer_load_dwordx4 v243, s[48:51], s29 offen lds
    s_add_u32 s29, s29, 14336
    v_mfma_f32_32x32x16_bf16 v[16:31], v[220:223], v[168:171], v[16:31]
    s_waitcnt lgkmcnt(2)
    v_mfma_f32_32x32x16_bf16 v[32:47], v[208:211], v[180:183], v[32:47]
    ds_read_b64_tr_b16 v[216:217], v234 offset:8192
    ds_read_b64_tr_b16 v[218:219], v234 offset:9216
    ds_read_b64_tr_b16 v[220:221], v235 offset:8192
    ds_read_b64_tr_b16 v[222:223], v235 offset:9216
    s_add_u32 m0, s17, 0
    s_waitcnt lgkmcnt(4)
    v_mfma_f32_32x32x16_bf16 v[48:63], v[212:215], v[180:183], v[48:63]
    buffer_load_dwordx4 v242, s[52:55], s15 offen lds
    s_add_u32 m0, s17, 1024
    v_mfma_f32_32x32x16_bf16 v[0:15], v[208:211], v[176:179], v[0:15]
    buffer_load_dwordx4 v243, s[52:55], s15 offen lds
    s_add_u32 s15, s15, 14336
    v_mfma_f32_32x32x16_bf16 v[16:31], v[212:215], v[176:179], v[16:31]
    s_waitcnt lgkmcnt(2)
    v_mfma_f32_32x32x16_bf16 v[32:47], v[216:219], v[188:191], v[32:47]
    ds_read_b64_tr_b16 v[208:209], v234 offset:16384
    ds_read_b64_tr_b16 v[210:211], v234 offset:17408
    ds_read_b64_tr_b16 v[212:213], v235 offset:16384
    ds_read_b64_tr_b16 v[214:215], v235 offset:17408
    s_add_u32 m0, s17, 8192
    s_waitcnt lgkmcnt(4)
    v_mfma_f32_32x32x16_bf16 v[48:63], v[220:223], v[188:191], v[48:63]
    buffer_load_dwordx4 v242, s[52:55], s15 offen lds
    s_add_u32 m0, s17, 9216
    v_mfma_f32_32x32x16_bf16 v[0:15], v[216:219], v[184:187], v[0:15]
    buffer_load_dwordx4 v243, s[52:55], s15 offen lds
    s_add_u32 s15, s15, 10752
    v_mfma_f32_32x32x16_bf16 v[16:31], v[220:223], v[184:187], v[16:31]
    s_waitcnt lgkmcnt(2)
    v_mfma_f32_32x32x16_bf16 v[32:47], v[208:211], v[196:199], v[32:47]
    ds_read_b64_tr_b16 v[216:217], v234 offset:24576
    ds_read_b64_tr_b16 v[218:219], v234 offset:25600
    ds_read_b64_tr_b16 v[220:221], v235 offset:24576
    ds_read_b64_tr_b16 v[222:223], v235 offset:25600
    s_add_u32 m0, s17, 16384
    s_waitcnt lgkmcnt(4)
    v_mfma_f32_32x32x16_bf16 v[48:63], v[212:215], v[196:199], v[48:63]
    buffer_load_dwordx4 v242, s[52:55], s15 offen lds
    s_add_u32 m0, s17, 17408
    v_mfma_f32_32x32x16_bf16 v[0:15], v[208:211], v[192:195], v[0:15]
    buffer_load_dwordx4 v243, s[52:55], s15 offen lds
    s_add_u32 s15, s15, 14336
    v_mfma_f32_32x32x16_bf16 v[16:31], v[212:215], v[192:195], v[16:31]
    s_waitcnt lgkmcnt(2)
    v_mfma_f32_32x32x16_bf16 v[32:47], v[216:219], v[204:207], v[32:47]
    ds_read_b64_tr_b16 v[208:209], v234 offset:32768
    ds_read_b64_tr_b16 v[210:211], v234 offset:33792
    ds_read_b64_tr_b16 v[212:213], v235 offset:32768
    ds_read_b64_tr_b16 v[214:215], v235 offset:33792
    s_add_u32 m0, s17, 24576
    s_waitcnt lgkmcnt(4)
    v_mfma_f32_32x32x16_bf16 v[48:63], v[220:223], v[204:207], v[48:63]
    buffer_load_dwordx4 v242, s[52:55], s15 offen lds
    s_add_u32 m0, s17, 25600
    v_mfma_f32_32x32x16_bf16 v[0:15], v[216:219], v[200:203], v[0:15]
    buffer_load_dwordx4 v243, s[52:55], s15 offen lds
    s_add_u32 s15, s15, 10752
    v_mfma_f32_32x32x16_bf16 v[16:31], v[220:223], v[200:203], v[16:31]
    s_waitcnt lgkmcnt(2)
    v_mfma_f32_32x32x16_bf16 v[32:47], v[208:211], v[68:71], v[32:47]
    ds_read_b64_tr_b16 v[216:217], v234 offset:40960
    ds_read_b64_tr_b16 v[218:219], v234 offset:41984
    ds_read_b64_tr_b16 v[220:221], v235 offset:40960
    ds_read_b64_tr_b16 v[222:223], v235 offset:41984
    s_add_u32 m0, s17, 32768
    s_waitcnt lgkmcnt(4)
    v_mfma_f32_32x32x16_bf16 v[48:63], v[212:215], v[68:71], v[48:63]
    buffer_load_dwordx4 v242, s[52:55], s15 offen lds
    s_add_u32 m0, s17, 33792
    v_mfma_f32_32x32x16_bf16 v[0:15], v[208:211], v[64:67], v[0:15]
    buffer_load_dwordx4 v243, s[52:55], s15 offen lds
    s_add_u32 s15, s15, 14336
    v_mfma_f32_32x32x16_bf16 v[16:31], v[212:215], v[64:67], v[16:31]
    s_waitcnt lgkmcnt(2)
    v_mfma_f32_32x32x16_bf16 v[32:47], v[216:219], v[76:79], v[32:47]
    ds_read_b64_tr_b16 v[208:209], v234 offset:49152
    ds_read_b64_tr_b16 v[210:211], v234 offset:50176
    ds_read_b64_tr_b16 v[212:213], v235 offset:49152
    ds_read_b64_tr_b16 v[214:215], v235 offset:50176
    s_add_u32 m0, s17, 40960
    s_waitcnt lgkmcnt(4)
    v_mfma_f32_32x32x16_bf16 v[48:63], v[220:223], v[76:79], v[48:63]
    buffer_load_dwordx4 v242, s[52:55], s15 offen lds
    s_add_u32 m0, s17, 41984
    v_mfma_f32_32x32x16_bf16 v[0:15], v[216:219], v[72:75], v[0:15]
    buffer_load_dwordx4 v243, s[52:55], s15 offen lds
    s_add_u32 s15, s15, 10752
    v_mfma_f32_32x32x16_bf16 v[16:31], v[220:223], v[72:75], v[16:31]
    s_waitcnt lgkmcnt(2)
    v_mfma_f32_32x32x16_bf16 v[32:47], v[208:211], v[84:87], v[32:47]
    ds_read_b64_tr_b16 v[216:217], v236 offset:0
    ds_read_b64_tr_b16 v[218:219], v236 offset:1024
    ds_read_b64_tr_b16 v[220:221], v237 offset:0
    ds_read_b64_tr_b16 v[222:223], v237 offset:1024
    s_add_u32 m0, s17, 49152
    s_waitcnt lgkmcnt(4)
    v_mfma_f32_32x32x16_bf16 v[48:63], v[212:215], v[84:87], v[48:63]
    buffer_load_dwordx4 v242, s[52:55], s15 offen lds
    s_add_u32 m0, s17, 50176
    v_mfma_f32_32x32x16_bf16 v[0:15], v[208:211], v[80:83], v[0:15]
    buffer_load_dwordx4 v243, s[52:55], s15 offen lds
    s_add_u32 s15, s15, 14336
    v_mfma_f32_32x32x16_bf16 v[16:31], v[212:215], v[80:83], v[16:31]
    s_waitcnt lgkmcnt(2)
    v_mfma_f32_32x32x16_bf16 v[32:47], v[216:219], v[92:95], v[32:47]
    ds_read_b64_tr_b16 v[208:209], v236 offset:8192
    ds_read_b64_tr_b16 v[210:211], v236 offset:9216
    ds_read_b64_tr_b16 v[212:213], v237 offset:8192
    ds_read_b64_tr_b16 v[214:215], v237 offset:9216
    s_add_u32 m0, s17, 57344
    s_waitcnt lgkmcnt(4)
    v_mfma_f32_32x32x16_bf16 v[48:63], v[220:223], v[92:95], v[48:63]
    buffer_load_dwordx4 v242, s[52:55], s15 offen lds
    s_add_u32 m0, s17, 58368
    v_mfma_f32_32x32x16_bf16 v[0:15], v[216:219], v[88:91], v[0:15]
    buffer_load_dwordx4 v243, s[52:55], s15 offen lds
    s_add_u32 s15, s15, 10752
    v_mfma_f32_32x32x16_bf16 v[16:31], v[220:223], v[88:91], v[16:31]
    s_waitcnt lgkmcnt(2)
    v_mfma_f32_32x32x16_bf16 v[32:47], v[208:211], v[100:103], v[32:47]
    s_waitcnt vmcnt(26)
    ds_read_b64_tr_b16 v[216:217], v236 offset:16384
    ds_read_b64_tr_b16 v[218:219], v236 offset:17408
    ds_read_b64_tr_b16 v[220:221], v237 offset:16384
    ds_read_b64_tr_b16 v[222:223], v237 offset:17408
    s_waitcnt lgkmcnt(4)
    v_mfma_f32_32x32x16_bf16 v[48:63], v[212:215], v[100:103], v[48:63]
    v_mfma_f32_32x32x16_bf16 v[0:15], v[208:211], v[96:99], v[0:15]
    v_mfma_f32_32x32x16_bf16 v[16:31], v[212:215], v[96:99], v[16:31]
    s_waitcnt lgkmcnt(2)
    v_mfma_f32_32x32x16_bf16 v[32:47], v[216:219], v[108:111], v[32:47]
    s_waitcnt vmcnt(22)
    ds_read_b64_tr_b16 v[208:209], v236 offset:24576
    ds_read_b64_tr_b16 v[210:211], v236 offset:25600
    ds_read_b64_tr_b16 v[212:213], v237 offset:24576
    ds_read_b64_tr_b16 v[214:215], v237 offset:25600
    s_waitcnt lgkmcnt(4)
    v_mfma_f32_32x32x16_bf16 v[48:63], v[220:223], v[108:111], v[48:63]
    v_mfma_f32_32x32x16_bf16 v[0:15], v[216:219], v[104:107], v[0:15]
    v_mfma_f32_32x32x16_bf16 v[16:31], v[220:223], v[104:107], v[16:31]
    s_waitcnt lgkmcnt(2)
    v_mfma_f32_32x32x16_bf16 v[32:47], v[208:211], v[116:119], v[32:47]
    s_waitcnt vmcnt(20)
    ds_read_b64_tr_b16 v[216:217], v236 offset:32768
    ds_read_b64_tr_b16 v[218:219], v236 offset:33792
    ds_read_b64_tr_b16 v[220:221], v237 offset:32768
    ds_read_b64_tr_b16 v[222:223], v237 offset:33792
    s_waitcnt lgkmcnt(4)
    v_mfma_f32_32x32x16_bf16 v[48:63], v[212:215], v[116:119], v[48:63]
    v_mfma_f32_32x32x16_bf16 v[0:15], v[208:211], v[112:115], v[0:15]
    v_mfma_f32_32x32x16_bf16 v[16:31], v[212:215], v[112:115], v[16:31]
    s_waitcnt lgkmcnt(2)
    v_mfma_f32_32x32x16_bf16 v[32:47], v[216:219], v[124:127], v[32:47]
    s_waitcnt vmcnt(18)
    ds_read_b64_tr_b16 v[208:209], v236 offset:40960
    ds_read_b64_tr_b16 v[210:211], v236 offset:41984
    ds_read_b64_tr_b16 v[212:213], v237 offset:40960
    ds_read_b64_tr_b16 v[214:215], v237 offset:41984
    s_waitcnt lgkmcnt(4)
    v_mfma_f32_32x32x16_bf16 v[48:63], v[220:223], v[124:127], v[48:63]
    v_mfma_f32_32x32x16_bf16 v[0:15], v[216:219], v[120:123], v[0:15]
    v_xor_b32 v248, 2048, v240
    v_xor_b32 v250, 6144, v240
    v_xor_b32 v255, 4096, v240
    s_mov_b32 s87, 0
    v_mfma_f32_32x32x16_bf16 v[16:31], v[220:223], v[120:123], v[16:31]
    v_subrev_u32 v238, s16, v234
    v_subrev_u32 v239, s16, v235
    v_subrev_u32 v251, s16, v236
    v_subrev_u32 v252, s16, v237
    s_waitcnt lgkmcnt(2)
    v_mfma_f32_32x32x16_bf16 v[32:47], v[208:211], v[132:135], v[32:47]
    s_waitcnt vmcnt(16)
    ds_read_b64_tr_b16 v[216:217], v236 offset:49152
    ds_read_b64_tr_b16 v[218:219], v236 offset:50176
    ds_read_b64_tr_b16 v[220:221], v237 offset:49152
    ds_read_b64_tr_b16 v[222:223], v237 offset:50176
    s_waitcnt lgkmcnt(4)
    v_mfma_f32_32x32x16_bf16 v[48:63], v[212:215], v[132:135], v[48:63]
    buffer_load_dwordx4 v[144:147], v244, s[44:47], s24 offen offset:0 sc1
    s_waitcnt vmcnt(1)
    s_barrier
    v_mfma_f32_32x32x16_bf16 v[0:15], v[208:211], v[128:131], v[0:15]
    ds_read_b64_tr_b16 v[64:65], v238 offset:0
    ds_read_b64_tr_b16 v[66:67], v238 offset:1024
    ds_read_b64_tr_b16 v[68:69], v239 offset:0
    ds_read_b64_tr_b16 v[70:71], v239 offset:1024
    v_mfma_f32_32x32x16_bf16 v[16:31], v[212:215], v[128:131], v[16:31]
    buffer_load_dwordx4 v[148:151], v244, s[44:47], s24 offen offset:1024 sc1
    ds_read_b64_tr_b16 v[72:73], v238 offset:8192
    ds_read_b64_tr_b16 v[74:75], v238 offset:9216
    ds_read_b64_tr_b16 v[76:77], v239 offset:8192
    ds_read_b64_tr_b16 v[78:79], v239 offset:9216
    s_waitcnt lgkmcnt(10)
    v_mfma_f32_32x32x16_bf16 v[32:47], v[216:219], v[140:143], v[32:47]
    s_waitcnt lgkmcnt(8)
    v_mfma_f32_32x32x16_bf16 v[48:63], v[220:223], v[140:143], v[48:63]
    buffer_load_dwordx4 v[152:155], v244, s[44:47], s24 offen offset:2048 sc1
    v_mfma_f32_32x32x16_bf16 v[0:15], v[216:219], v[136:139], v[0:15]
    ds_read_b64_tr_b16 v[80:81], v238 offset:16384
    ds_read_b64_tr_b16 v[82:83], v238 offset:17408
    ds_read_b64_tr_b16 v[84:85], v239 offset:16384
    ds_read_b64_tr_b16 v[86:87], v239 offset:17408
    v_mfma_f32_32x32x16_bf16 v[16:31], v[220:223], v[136:139], v[16:31]
    buffer_load_dwordx4 v[156:159], v244, s[44:47], s24 offen offset:3072 sc1
    ds_read_b64_tr_b16 v[88:89], v238 offset:24576
    ds_read_b64_tr_b16 v[90:91], v238 offset:25600
    ds_read_b64_tr_b16 v[92:93], v239 offset:24576
    ds_read_b64_tr_b16 v[94:95], v239 offset:25600
    ds_read_b64_tr_b16 v[96:97], v238 offset:32768
    ds_read_b64_tr_b16 v[98:99], v238 offset:33792
    ds_read_b64_tr_b16 v[100:101], v239 offset:32768
    ds_read_b64_tr_b16 v[102:103], v239 offset:33792
    ds_read_b64_tr_b16 v[104:105], v238 offset:40960
    ds_read_b64_tr_b16 v[106:107], v238 offset:41984
    ds_read_b64_tr_b16 v[108:109], v239 offset:40960
    ds_read_b64_tr_b16 v[110:111], v239 offset:41984
    ds_write_b128 v240, v[32:35] offset:0
    buffer_load_dwordx4 v[160:163], v244, s[44:47], s25 offen offset:0 sc1
    ds_write_b128 v240, v[36:39] offset:1024
    ds_write_b128 v240, v[40:43] offset:8192
    buffer_load_dwordx4 v[164:167], v244, s[44:47], s25 offen offset:1024 sc1
    ds_write_b128 v240, v[44:47] offset:9216
    ds_write_b128 v240, v[48:51] offset:16384
    buffer_load_dwordx4 v[168:171], v244, s[44:47], s25 offen offset:2048 sc1
    ds_write_b128 v240, v[52:55] offset:17408
    ds_write_b128 v240, v[56:59] offset:24576
    buffer_load_dwordx4 v[172:175], v244, s[44:47], s25 offen offset:3072 sc1
    ds_write_b128 v240, v[60:63] offset:25600
    s_waitcnt vmcnt(6)
    v_max_u32 v249, v144, v145
    v_max3_u32 v249, v146, v147, v249
    v_max3_u32 v249, v148, v149, v249
    v_max3_u32 v249, v150, v151, v249
    v_cmp_eq_u32 vcc, -1, v249
    s_nop 2
    s_cbranch_vccnz L_or0
L_ok0:
    s_waitcnt lgkmcnt(14)
    v_mfma_f32_32x32x16_bf16 v[16:31], v[68:71], v[144:147], v[16:31]
    buffer_load_dwordx4 v[176:179], v244, s[44:47], s26 offen offset:0 sc1
    ds_read_b64_tr_b16 v[112:113], v238 offset:49152
    ds_read_b64_tr_b16 v[114:115], v238 offset:50176
    ds_read_b64_tr_b16 v[116:117], v239 offset:49152
    ds_read_b64_tr_b16 v[118:119], v239 offset:50176
    v_mfma_f32_32x32x16_bf16 v[0:15], v[64:67], v[144:147], v[0:15]
    s_waitcnt vmcnt(5)
    v_max_u32 v249, v152, v153
    v_max3_u32 v249, v154, v155, v249
    v_max3_u32 v249, v156, v157, v249
    v_max3_u32 v249, v158, v159, v249
    v_cmp_eq_u32 vcc, -1, v249
    v_mfma_f32_32x32x16_bf16 v[16:31], v[76:79], v[148:151], v[16:31]
    buffer_load_dwordx4 v[180:183], v244, s[44:47], s26 offen offset:1024 sc1
    ds_read_b64_tr_b16 v[120:121], v251 offset:0
    ds_read_b64_tr_b16 v[122:123], v251 offset:1024
    ds_read_b64_tr_b16 v[124:125], v252 offset:0
    ds_read_b64_tr_b16 v[126:127], v252 offset:1024
    s_cbranch_vccnz L_or1
L_ok1:
    v_mfma_f32_32x32x16_bf16 v[0:15], v[72:75], v[148:151], v[0:15]
    v_mfma_f32_32x32x16_bf16 v[16:31], v[84:87], v[152:155], v[16:31]
    buffer_load_dwordx4 v[184:187], v244, s[44:47], s26 offen offset:2048 sc1
    ds_read_b64_tr_b16 v[64:65], v238 offset:2048
    ds_read_b64_tr_b16 v[66:67], v238 offset:3072
    ds_read_b64_tr_b16 v[68:69], v239 offset:2048
    ds_read_b64_tr_b16 v[70:71], v239 offset:3072
    v_mfma_f32_32x32x16_bf16 v[0:15], v[80:83], v[152:155], v[0:15]
    s_waitcnt vmcnt(5)
    v_max_u32 v249, v160, v161
    v_max3_u32 v249, v162, v163, v249
    v_max3_u32 v249, v164, v165, v249
    v_max3_u32 v249, v166, v167, v249
    v_cmp_eq_u32 vcc, -1, v249
    v_mfma_f32_32x32x16_bf16 v[16:31], v[92:95], v[156:159], v[16:31]
    buffer_load_dwordx4 v[188:191], v244, s[44:47], s26 offen offset:3072 sc1
    ds_read_b64_tr_b16 v[72:73], v238 offset:10240
    ds_read_b64_tr_b16 v[74:75], v238 offset:11264
    ds_read_b64_tr_b16 v[76:77], v239 offset:10240
    ds_read_b64_tr_b16 v[78:79], v239 offset:11264
    s_cbranch_vccnz L_or2
L_ok2:
    v_mfma_f32_32x32x16_bf16 v[0:15], v[88:91], v[156:159], v[0:15]
    s_waitcnt lgkmcnt(14)
    v_mfma_f32_32x32x16_bf16 v[16:31], v[100:103], v[160:163], v[16:31]
    buffer_load_dwordx4 v[192:195], v244, s[44:47], s27 offen offset:0 sc1
    ds_read_b64_tr_b16 v[80:81], v238 offset:18432
    ds_read_b64_tr_b16 v[82:83], v238 offset:19456
    ds_read_b64_tr_b16 v[84:85], v239 offset:18432
    ds_read_b64_tr_b16 v[86:87], v239 offset:19456
    v_mfma_f32_32x32x16_bf16 v[0:15], v[96:99], v[160:163], v[0:15]
    s_waitcnt vmcnt(5)
    v_max_u32 v249, v168, v169
    v_max3_u32 v249, v170, v171, v249
    v_max3_u32 v249, v172, v173, v249
    v_max3_u32 v249, v174, v175, v249
    v_cmp_eq_u32 vcc, -1, v249
    v_mfma_f32_32x32x16_bf16 v[16:31], v[108:111], v[164:167], v[16:31]
    buffer_load_dwordx4 v[196:199], v244, s[44:47], s27 offen offset:1024 sc1
    ds_read_b64_tr_b16 v[88:89], v238 offset:26624
    ds_read_b64_tr_b16 v[90:91], v238 offset:27648
    ds_read_b64_tr_b16 v[92:93], v239 offset:26624
    ds_read_b64_tr_b16 v[94:95], v239 offset:27648
    s_cbranch_vccnz L_or3
L_ok3:
    v_mfma_f32_32x32x16_bf16 v[0:15], v[104:107], v[164:167], v[0:15]
    s_barrier
    ds_read_b128 v[32:35], v248 offset:0
    ds_read_b128 v[48:51], v250 offset:16384
    ds_read_b128 v[36:39], v248 offset:1024
    ds_read_b128 v[52:55], v250 offset:17408
    s_waitcnt lgkmcnt(14)
    v_mfma_f32_32x32x16_bf16 v[16:31], v[116:119], v[168:171], v[16:31]
    buffer_load_dwordx4 v[200:203], v244, s[44:47], s27 offen offset:2048 sc1
    ds_read_b64_tr_b16 v[96:97], v238 offset:34816
    ds_read_b64_tr_b16 v[98:99], v238 offset:35840
    ds_read_b64_tr_b16 v[100:101], v239 offset:34816
    ds_read_b64_tr_b16 v[102:103], v239 offset:35840
    v_mfma_f32_32x32x16_bf16 v[0:15], v[112:115], v[168:171], v[0:15]
    s_waitcnt vmcnt(5)
    v_max_u32 v249, v176, v177
    v_max3_u32 v249, v178, v179, v249
    v_max3_u32 v249, v180, v181, v249
    v_max3_u32 v249, v182, v183, v249
    v_cmp_eq_u32 vcc, -1, v249
    v_mfma_f32_32x32x16_bf16 v[16:31], v[124:127], v[172:175], v[16:31]
    buffer_load_dwordx4 v[204:207], v244, s[44:47], s27 offen offset:3072 sc1
    ds_read_b64_tr_b16 v[104:105], v238 offset:43008
    ds_read_b64_tr_b16 v[106:107], v238 offset:44032
    ds_read_b64_tr_b16 v[108:109], v239 offset:43008
    ds_read_b64_tr_b16 v[110:111], v239 offset:44032
    s_cbranch_vccnz L_or4
L_ok4:
    v_mfma_f32_32x32x16_bf16 v[0:15], v[120:123], v[172:175], v[0:15]
    ds_read_b128 v[40:43], v248 offset:8192
    ds_read_b128 v[56:59], v250 offset:24576
    ds_read_b128 v[44:47], v248 offset:9216
    ds_read_b128 v[60:63], v250 offset:25600
    v_mfma_f32_32x32x16_bf16 v[16:31], v[68:71], v[176:179], v[16:31]
    ds_read_b64_tr_b16 v[112:113], v238 offset:51200
    ds_read_b64_tr_b16 v[114:115], v238 offset:52224
    ds_read_b64_tr_b16 v[116:117], v239 offset:51200
    ds_read_b64_tr_b16 v[118:119], v239 offset:52224
    v_mfma_f32_32x32x16_bf16 v[0:15], v[64:67], v[176:179], v[0:15]
    s_waitcnt vmcnt(4)
    v_max_u32 v249, v184, v185
    v_max3_u32 v249, v186, v187, v249
    v_max3_u32 v249, v188, v189, v249
    v_max3_u32 v249, v190, v191, v249
    v_cmp_eq_u32 vcc, -1, v249
    s_waitcnt lgkmcnt(14)
    v_mfma_f32_32x32x16_bf16 v[16:31], v[76:79], v[180:183], v[16:31]
    ds_read_b64_tr_b16 v[120:121], v251 offset:2048
    ds_read_b64_tr_b16 v[122:123], v251 offset:3072
    ds_read_b64_tr_b16 v[124:125], v252 offset:2048
    ds_read_b64_tr_b16 v[126:127], v252 offset:3072
    s_cbranch_vccnz L_or5
L_ok5:
    v_mfma_f32_32x32x16_bf16 v[0:15], v[72:75], v[180:183], v[0:15]
    v_mfma_f32_32x32x16_bf16 v[16:31], v[84:87], v[184:187], v[16:31]
    v_mfma_f32_32x32x16_bf16 v[0:15], v[80:83], v[184:187], v[0:15]
    s_waitcnt vmcnt(2)
    v_max_u32 v249, v192, v193
    v_max3_u32 v249, v194, v195, v249
    v_max3_u32 v249, v196, v197, v249
    v_max3_u32 v249, v198, v199, v249
    v_cmp_eq_u32 vcc, -1, v249
    v_mfma_f32_32x32x16_bf16 v[16:31], v[92:95], v[188:191], v[16:31]
    s_nop 1
    s_cbranch_vccnz L_or6
L_ok6:
    v_mfma_f32_32x32x16_bf16 v[0:15], v[88:91], v[188:191], v[0:15]
    s_waitcnt lgkmcnt(14)
    v_mfma_f32_32x32x16_bf16 v[16:31], v[100:103], v[192:195], v[16:31]
    v_mfma_f32_32x32x16_bf16 v[0:15], v[96:99], v[192:195], v[0:15]
    s_waitcnt vmcnt(0)
    v_max_u32 v249, v200, v201
    v_max3_u32 v249, v202, v203, v249
    v_max3_u32 v249, v204, v205, v249
    v_max3_u32 v249, v206, v207, v249
    v_cmp_eq_u32 vcc, -1, v249
    s_waitcnt lgkmcnt(12)
    v_mfma_f32_32x32x16_bf16 v[16:31], v[108:111], v[196:199], v[16:31]
    s_nop 0
    s_cbranch_vccnz L_or7
L_ok7:
    s_waitcnt lgkmcnt(4)
    v_mfma_f32_32x32x16_bf16 v[16:31], v[116:119], v[200:203], v[16:31]
    v_add_f32 v32, v32, v48
    v_add_f32 v33, v33, v49
    v_add_f32 v34, v34, v50
    v_add_f32 v35, v35, v51
    v_add_f32 v36, v36, v52
    s_waitcnt lgkmcnt(0)
    v_mfma_f32_32x32x16_bf16 v[16:31], v[124:127], v[204:207], v[16:31]
    v_add_f32 v37, v37, v53
    v_add_f32 v38, v38, v54
    v_add_f32 v39, v39, v55
    v_add_f32 v40, v40, v56
    v_add_f32 v41, v41, v57
    v_mfma_f32_32x32x16_bf16 v[0:15], v[104:107], v[196:199], v[0:15]
    v_add_f32 v42, v42, v58
    v_add_f32 v43, v43, v59
    v_add_f32 v44, v44, v60
    v_add_f32 v45, v45, v61
    v_add_f32 v46, v46, v62
    v_add_f32 v47, v47, v63
    v_mfma_f32_32x32x16_bf16 v[0:15], v[112:115], v[200:203], v[0:15]
    ds_write_b128 v240, v[16:19] offset:32768
    ds_write_b128 v240, v[20:23] offset:33792
    v_mfma_f32_32x32x16_bf16 v[0:15], v[120:123], v[204:207], v[0:15]
    ds_write_b128 v240, v[24:27] offset:40960
    ds_write_b128 v240, v[28:31] offset:41984
    s_nop 9
    v_add_f32 v0, v0, v32
    v_add_f32 v1, v1, v33
    v_add_f32 v2, v2, v34
    v_add_f32 v3, v3, v35
    v_add_f32 v4, v4, v36
    v_add_f32 v5, v5, v37
    v_add_f32 v6, v6, v38
    v_add_f32 v7, v7, v39
    v_add_f32 v8, v8, v40
    v_add_f32 v9, v9, v41
    v_add_f32 v10, v10, v42
    v_add_f32 v11, v11, v43
    v_add_f32 v12, v12, v44
    v_add_f32 v13, v13, v45
    v_add_f32 v14, v14, v46
    v_add_f32 v15, v15, v47
    s_waitcnt lgkmcnt(0)
    s_barrier
    ds_read_b128 v[16:19], v255 offset:32768
    ds_read_b128 v[20:23], v255 offset:33792
    ds_read_b128 v[24:27], v255 offset:40960
    ds_read_b128 v[28:31], v255 offset:41984
    s_waitcnt lgkmcnt(3)
    v_add_f32 v0, v0, v16
    v_add_f32 v1, v1, v17
    v_add_f32 v2, v2, v18
    v_add_f32 v3, v3, v19
    s_waitcnt lgkmcnt(2)
    v_add_f32 v4, v4, v20
    v_add_f32 v5, v5, v21
    v_add_f32 v6, v6, v22
    v_add_f32 v7, v7, v23
    v_cvt_pk_bf16_f32 v32, v0, v1
    v_cvt_pk_bf16_f32 v33, v2, v3
    v_cvt_pk_bf16_f32 v34, v4, v5
    v_cvt_pk_bf16_f32 v35, v6, v7
    s_nop 0
    v_permlane32_swap_b32 v32, v34
    v_permlane32_swap_b32 v33, v35
    buffer_store_dwordx4 v[32:35], v241, s[56:59], 0 offen offset:0
    s_waitcnt lgkmcnt(1)
    v_add_f32 v8, v8, v24
    v_add_f32 v9, v9, v25
    v_add_f32 v10, v10, v26
    v_add_f32 v11, v11, v27
    s_waitcnt lgkmcnt(0)
    v_add_f32 v12, v12, v28
    v_add_f32 v13, v13, v29
    v_add_f32 v14, v14, v30
    v_add_f32 v15, v15, v31
    v_cvt_pk_bf16_f32 v36, v8, v9
    v_cvt_pk_bf16_f32 v37, v10, v11
    v_cvt_pk_bf16_f32 v38, v12, v13
    v_cvt_pk_bf16_f32 v39, v14, v15
    s_nop 0
    v_permlane32_swap_b32 v36, v38
    v_permlane32_swap_b32 v37, v39
    buffer_store_dwordx4 v[36:39], v241, s[56:59], 0 offen offset:32
    s_endpgm
L_or0:
    s_add_u32 s87, s87, 1
    s_cmp_ge_u32 s87, 50000
    s_cbranch_scc1 L_ok0
    buffer_load_dwordx4 v[144:147], v244, s[44:47], s24 offen offset:0 sc1
    buffer_load_dwordx4 v[148:151], v244, s[44:47], s24 offen offset:1024 sc1
    buffer_load_dwordx4 v[152:155], v244, s[44:47], s24 offen offset:2048 sc1
    buffer_load_dwordx4 v[156:159], v244, s[44:47], s24 offen offset:3072 sc1
    buffer_load_dwordx4 v[160:163], v244, s[44:47], s25 offen offset:0 sc1
    buffer_load_dwordx4 v[164:167], v244, s[44:47], s25 offen offset:1024 sc1
    buffer_load_dwordx4 v[168:171], v244, s[44:47], s25 offen offset:2048 sc1
    buffer_load_dwordx4 v[172:175], v244, s[44:47], s25 offen offset:3072 sc1
    s_waitcnt vmcnt(6)
    v_max_u32 v249, v144, v145
    v_max3_u32 v249, v146, v147, v249
    v_max3_u32 v249, v148, v149, v249
    v_max3_u32 v249, v150, v151, v249
    v_cmp_eq_u32 vcc, -1, v249
    s_nop 2
    s_cbranch_vccnz L_or0
    s_branch L_ok0
L_or1:
    s_add_u32 s87, s87, 1
    s_cmp_ge_u32 s87, 50000
    s_cbranch_scc1 L_ok1
    buffer_load_dwordx4 v[152:155], v244, s[44:47], s24 offen offset:2048 sc1
    buffer_load_dwordx4 v[156:159], v244, s[44:47], s24 offen offset:3072 sc1
    buffer_load_dwordx4 v[160:163], v244, s[44:47], s25 offen offset:0 sc1
    buffer_load_dwordx4 v[164:167], v244, s[44:47], s25 offen offset:1024 sc1
    buffer_load_dwordx4 v[168:171], v244, s[44:47], s25 offen offset:2048 sc1
    buffer_load_dwordx4 v[172:175], v244, s[44:47], s25 offen offset:3072 sc1
    buffer_load_dwordx4 v[176:179], v244, s[44:47], s26 offen offset:0 sc1
    buffer_load_dwordx4 v[180:183], v244, s[44:47], s26 offen offset:1024 sc1
    s_waitcnt vmcnt(6)
    v_max_u32 v249, v152, v153
    v_max3_u32 v249, v154, v155, v249
    v_max3_u32 v249, v156, v157, v249
    v_max3_u32 v249, v158, v159, v249
    v_cmp_eq_u32 vcc, -1, v249
    s_nop 2
    s_cbranch_vccnz L_or1
    s_branch L_ok1
L_or2:
    s_add_u32 s87, s87, 1
    s_cmp_ge_u32 s87, 50000
    s_cbranch_scc1 L_ok2
    buffer_load_dwordx4 v[160:163], v244, s[44:47], s25 offen offset:0 sc1
    buffer_load_dwordx4 v[164:167], v244, s[44:47], s25 offen offset:1024 sc1
    buffer_load_dwordx4 v[168:171], v244, s[44:47], s25 offen offset:2048 sc1
    buffer_load_dwordx4 v[172:175], v244, s[44:47], s25 offen offset:3072 sc1
    buffer_load_dwordx4 v[176:179], v244, s[44:47], s26 offen offset:0 sc1
    buffer_load_dwordx4 v[180:183], v244, s[44:47], s26 offen offset:1024 sc1
    buffer_load_dwordx4 v[184:187], v244, s[44:47], s26 offen offset:2048 sc1
    buffer_load_dwordx4 v[188:191], v244, s[44:47], s26 offen offset:3072 sc1
    s_waitcnt vmcnt(6)
    v_max_u32 v249, v160, v161
    v_max3_u32 v249, v162, v163, v249
    v_max3_u32 v249, v164, v165, v249
    v_max3_u32 v249, v166, v167, v249
    v_cmp_eq_u32 vcc, -1, v249
    s_nop 2
    s_cbranch_vccnz L_or2
    s_branch L_ok2
L_or3:
    s_add_u32 s87, s87, 1
    s_cmp_ge_u32 s87, 50000
    s_cbranch_scc1 L_ok3
    buffer_load_dwordx4 v[168:171], v244, s[44:47], s25 offen offset:2048 sc1
    buffer_load_dwordx4 v[172:175], v244, s[44:47], s25 offen offset:3072 sc1
    buffer_load_dwordx4 v[176:179], v244, s[44:47], s26 offen offset:0 sc1
    buffer_load_dwordx4 v[180:183], v244, s[44:47], s26 offen offset:1024 sc1
    buffer_load_dwordx4 v[184:187], v244, s[44:47], s26 offen offset:2048 sc1
    buffer_load_dwordx4 v[188:191], v244, s[44:47], s26 offen offset:3072 sc1
    buffer_load_dwordx4 v[192:195], v244, s[44:47], s27 offen offset:0 sc1
    buffer_load_dwordx4 v[196:199], v244, s[44:47], s27 offen offset:1024 sc1
    s_waitcnt vmcnt(6)
    v_max_u32 v249, v168, v169
    v_max3_u32 v249, v170, v171, v249
    v_max3_u32 v249, v172, v173, v249
    v_max3_u32 v249, v174, v175, v249
    v_cmp_eq_u32 vcc, -1, v249
    s_nop 2
    s_cbranch_vccnz L_or3
    s_branch L_ok3
L_or4:
    s_add_u32 s87, s87, 1
    s_cmp_ge_u32 s87, 50000
    s_cbranch_scc1 L_ok4
    buffer_load_dwordx4 v[176:179], v244, s[44:47], s26 offen offset:0 sc1
    buffer_load_dwordx4 v[180:183], v244, s[44:47], s26 offen offset:1024 sc1
    buffer_load_dwordx4 v[184:187], v244, s[44:47], s26 offen offset:2048 sc1
    buffer_load_dwordx4 v[188:191], v244, s[44:47], s26 offen offset:3072 sc1
    buffer_load_dwordx4 v[192:195], v244, s[44:47], s27 offen offset:0 sc1
    buffer_load_dwordx4 v[196:199], v244, s[44:47], s27 offen offset:1024 sc1
    buffer_load_dwordx4 v[200:203], v244, s[44:47], s27 offen offset:2048 sc1
    buffer_load_dwordx4 v[204:207], v244, s[44:47], s27 offen offset:3072 sc1
    s_waitcnt vmcnt(6)
    v_max_u32 v249, v176, v177
    v_max3_u32 v249, v178, v179, v249
    v_max3_u32 v249, v180, v181, v249
    v_max3_u32 v249, v182, v183, v249
    v_cmp_eq_u32 vcc, -1, v249
    s_nop 2
    s_cbranch_vccnz L_or4
    s_branch L_ok4
L_or5:
    s_add_u32 s87, s87, 1
    s_cmp_ge_u32 s87, 50000
    s_cbranch_scc1 L_ok5
    buffer_load_dwordx4 v[184:187], v244, s[44:47], s26 offen offset:2048 sc1
    buffer_load_dwordx4 v[188:191], v244, s[44:47], s26 offen offset:3072 sc1
    buffer_load_dwordx4 v[192:195], v244, s[44:47], s27 offen offset:0 sc1
    buffer_load_dwordx4 v[196:199], v244, s[44:47], s27 offen offset:1024 sc1
    buffer_load_dwordx4 v[200:203], v244, s[44:47], s27 offen offset:2048 sc1
    buffer_load_dwordx4 v[204:207], v244, s[44:47], s27 offen offset:3072 sc1
    s_waitcnt vmcnt(4)
    v_max_u32 v249, v184, v185
    v_max3_u32 v249, v186, v187, v249
    v_max3_u32 v249, v188, v189, v249
    v_max3_u32 v249, v190, v191, v249
    v_cmp_eq_u32 vcc, -1, v249
    s_nop 2
    s_cbranch_vccnz L_or5
    s_branch L_ok5
L_or6:
    s_add_u32 s87, s87, 1
    s_cmp_ge_u32 s87, 50000
    s_cbranch_scc1 L_ok6
    buffer_load_dwordx4 v[192:195], v244, s[44:47], s27 offen offset:0 sc1
    buffer_load_dwordx4 v[196:199], v244, s[44:47], s27 offen offset:1024 sc1
    buffer_load_dwordx4 v[200:203], v244, s[44:47], s27 offen offset:2048 sc1
    buffer_load_dwordx4 v[204:207], v244, s[44:47], s27 offen offset:3072 sc1
    s_waitcnt vmcnt(2)
    v_max_u32 v249, v192, v193
    v_max3_u32 v249, v194, v195, v249
    v_max3_u32 v249, v196, v197, v249
    v_max3_u32 v249, v198, v199, v249
    v_cmp_eq_u32 vcc, -1, v249
    s_nop 2
    s_cbranch_vccnz L_or6
    s_branch L_ok6
L_or7:
    s_add_u32 s87, s87, 1
    s_cmp_ge_u32 s87, 50000
    s_cbranch_scc1 L_ok7
    buffer_load_dwordx4 v[200:203], v244, s[44:47], s27 offen offset:2048 sc1
    buffer_load_dwordx4 v[204:207], v244, s[44:47], s27 offen offset:3072 sc1
    s_waitcnt vmcnt(0)
    v_max_u32 v249, v200, v201
    v_max3_u32 v249, v202, v203, v249
    v_max3_u32 v249, v204, v205, v249
    v_max3_u32 v249, v206, v207, v249
    v_cmp_eq_u32 vcc, -1, v249
    s_nop 2
    s_cbranch_vccnz L_or7
    s_branch L_ok7
L_idle:
    s_cmp_lg_u32 s2, 255
    s_cbranch_scc1 L_end
    s_cmp_lg_u32 s60, 4
    s_cbranch_scc1 L_end
    s_mov_b32 s87, 0
    v_lshlrev_b32 v200, 7, v245
    v_add_u32 v203, 28672, v200
    v_add_u32 v202, 20480, v200
    v_add_u32 v201, 12288, v200
    v_add_u32 v200, 4096, v200
L_idle1:
    buffer_load_dword v204, v200, s[44:47], 0 offen sc1
    buffer_load_dword v205, v201, s[44:47], 0 offen sc1
    buffer_load_dword v206, v202, s[44:47], 0 offen sc1
    buffer_load_dword v207, v203, s[44:47], 0 offen sc1
    s_add_u32 s87, s87, 1
    s_waitcnt vmcnt(0)
    v_xor_b32 v204, s63, v204
    v_xor_b32 v205, s63, v205
    v_xor_b32 v206, s63, v206
    v_xor_b32 v207, s63, v207
    v_or3_b32 v204, v204, v205, v206
    v_or_b32 v204, v204, v207
    v_cmp_ne_u32 vcc, 0, v204
    s_cmp_lt_u32 s87, 100000
    s_cselect_b64 s[84:85], -1, 0
    s_nop 0
    s_and_b64 vcc, vcc, s[84:85]
    s_cbranch_vccnz L_idle1
    s_mov_b64 exec, 1
    buffer_store_dword v246, v244, s[44:47], 0 offen sc1
L_end:
    s_endpgm
.section .rodata,"a"
.p2align 6
.amdhsa_kernel parallel_sum__softmax_full_mha__glu_gated_reglu__prompt_kernel
  .amdhsa_next_free_vgpr 256
  .amdhsa_next_free_sgpr 102
  .amdhsa_accum_offset 256
  .amdhsa_group_segment_fixed_size 0
  .amdhsa_kernarg_size 80
  .amdhsa_user_sgpr_count 2
  .amdhsa_user_sgpr_kernarg_segment_ptr 1
  .amdhsa_system_sgpr_workgroup_id_x 1
.end_amdhsa_kernel
```
